```python
import torch

def _softmax(x, axis=-1):
    return torch.softmax(x, dim=axis)
def _gelu(x):
    return torch.nn.functional.gelu(x, approximate="tanh")
def _silu(x):
    return torch.nn.functional.silu(x)
def _sigmoid(x):
    return torch.sigmoid(x)
def _layernorm(x, axis=-1, eps=1e-5):
    m = x.mean(dim=axis, keepdim=True)
    v = x.var(dim=axis, keepdim=True, unbiased=False)
    return (x - m) / torch.sqrt(v + eps)
def _scatter_add(tgt, idx, src, axis=0):
    return tgt.clone().index_add_(axis, idx, src)
def _segment_sum(src, seg, n):
    out = torch.zeros((n,) + src.shape[1:], dtype=src.dtype)
    return out.index_add_(0, seg, src)
def _pad(x, pw):
    flat = tuple(v for pair in reversed(pw) for v in pair)
    return torch.nn.functional.pad(x, flat)

kernel_name = 'standalone__gqa_softmax__near_ridge'

def setup_inputs():

    _w = (lambda a: (lambda t: t.to(torch.bfloat16) if t.is_floating_point() else t)(torch.as_tensor(a)))
    B, Hq, Hkv, Sq, Sk, D = 16, 32, 16, 496, 512, 128
    return {
        "q": _w((lambda *s: torch.randn(*s, dtype=torch.bfloat16) * 0.8)(B, Hq, Sq, D)),
        "k": _w((lambda *s: torch.randn(*s, dtype=torch.bfloat16) * 0.8)(B, Hkv, Sk, D)),
        "v": _w((lambda *s: torch.randn(*s, dtype=torch.bfloat16) * 0.05)(B, Hkv, Sk, D)),
    }

def reference(q, k, v):
    B, Hq, Sq, D = q.shape
    Hkv = k.shape[1]
    rep = Hq // Hkv
    k = (lambda x, n, axis: torch.repeat_interleave(x, n, dim=axis))(k, rep, axis=1)
    v = (lambda x, n, axis: torch.repeat_interleave(x, n, dim=axis))(v, rep, axis=1)
    scale = D ** -0.5
    scores = torch.einsum("bhqd,bhkd->bhqk", q, k) * scale
    p = _softmax(scores, axis=-1)
    return torch.einsum("bhqk,bhkd->bhqd", p, v)
```

```asm
; @launch grid=(256,1,1) block=(256,1,1) lds=163840
.amdgcn_target "amdgcn-amd-amdhsa--gfx950"
.text
.globl standalone__gqa_softmax__near_ridge_kernel
.p2align 8
.type standalone__gqa_softmax__near_ridge_kernel,@function
standalone__gqa_softmax__near_ridge_kernel:
    s_cmp_ge_u32 s2, 256
    s_cbranch_scc1 L_end

    s_load_dwordx4 s[56:59], s[0:1], 0
    s_load_dwordx4 s[60:63], s[0:1], 16
    s_getpc_b64 s[94:95]
L_pc:
    s_bfe_u32 s64, s2, 0x20003
    s_lshl_b32 s64, s64, 13
    v_lshlrev_b32 v28, 7, v0
    v_cmp_lt_u32 vcc, 63, v0
    v_mov_b32 v29, s64
    s_nop 0
    v_cndmask_b32 v29, 0, v29, vcc
    v_add_u32 v28, v28, v29
    v_min_u32 v28, L_end-L_pc, v28
    v_cmp_gt_u32 vcc, 128, v0
    s_and_saveexec_b64 s[64:65], vcc
    s_cbranch_execz L_w1
    global_load_dword a255, v28, s[94:95]
L_w1:
    s_mov_b64 exec, -1
    v_lshrrev_b32 v20, 6, v0
    v_and_b32 v21, 63, v0
    v_readfirstlane_b32 s42, v20
    v_and_b32 v22, 15, v21
    v_lshrrev_b32 v23, 4, v21
    v_lshrrev_b32 v26, 2, v22
    v_and_b32 v27, 3, v21
    v_lshlrev_b32 v30, 8, v26
    v_lshl_add_u32 v30, v23, 6, v30
    v_lshl_add_u32 v5, v27, 4, v30
    v_xor_b32 v6, 48, v5
    v_xor_b32 v7, 32, v5
    v_xor_b32 v8, 16, v5
    s_and_b32 s43, s2, 7
    s_lshr_b32 s44, s2, 3
    s_lshr_b32 s45, s44, 2
    s_and_b32 s44, s44, 3
    s_lshl_b32 s43, s43, 5
    s_lshl_b32 s45, s45, 2
    s_add_u32 s43, s43, s45
    s_lshl_b32 s39, s42, 12
    s_lshl_b32 s29, s43, 17
    s_add_u32 s29, s29, s39
    s_mul_i32 s45, s43, 253952
    s_lshl_b32 s46, s44, 16
    s_add_u32 s45, s45, s46
    s_lshl_b32 s46, s42, 14
    s_add_u32 s30, s45, s46
    s_add_u32 s31, s30, 4096
    s_lshl_b32 s66, s42, 13
    s_add_u32 s66, s66, 131072
    s_lshl_b32 s46, s44, 2
    s_add_u32 s46, s46, s42
    s_cmp_eq_u32 s46, 15
    s_cselect_b32 s46, 0x40000000, 8192
    s_cselect_b32 s47, 0xff800000, 0
    s_cselect_b32 s45, 0, 8192
    s_cselect_b32 s70, 0, 65011712
    s_add_u32 s64, s30, s45
    s_add_u32 s65, s31, s45
    s_mov_b32 s6, 65011712
    s_mov_b32 s7, 0x20000
    s_mov_b32 s71, 0x20000
    s_mov_b32 s22, 33554432
    s_mov_b32 s23, 0x20000
    s_mov_b32 s26, 33554432
    s_mov_b32 s27, 0x20000
    s_waitcnt lgkmcnt(0)
    s_mov_b32 s20, s58
    s_mov_b32 s21, s59
    s_mov_b32 s4, s56
    s_mov_b32 s5, s57
    s_mov_b32 s68, s56
    s_mov_b32 s69, s57
    s_mov_b32 s24, s60
    s_mov_b32 s25, s61
    s_add_u32 s40, s29, 0
    s_add_u32 m0, s39, 0
    s_nop 0
    buffer_load_dwordx4 v5, s[20:23], s40 offen offset:0 nt lds
    buffer_load_dwordx4 v6, s[20:23], s40 offen offset:1024 nt lds
    buffer_load_dwordx4 v7, s[20:23], s40 offen offset:2048 nt lds
    buffer_load_dwordx4 v8, s[20:23], s40 offen offset:3072 nt lds
    s_add_u32 m0, s66, 0
    s_nop 0
    buffer_load_dwordx4 v5, s[4:7], s30 offen offset:0 nt lds
    buffer_load_dwordx4 v6, s[4:7], s30 offen offset:1024 nt lds
    buffer_load_dwordx4 v7, s[4:7], s30 offen offset:2048 nt lds
    buffer_load_dwordx4 v8, s[4:7], s30 offen offset:3072 nt lds
    s_add_u32 s40, s29, 16384
    s_add_u32 m0, s39, 16384
    s_nop 0
    buffer_load_dwordx4 v5, s[20:23], s40 offen offset:0 nt lds
    buffer_load_dwordx4 v6, s[20:23], s40 offen offset:1024 nt lds
    buffer_load_dwordx4 v7, s[20:23], s40 offen offset:2048 nt lds
    buffer_load_dwordx4 v8, s[20:23], s40 offen offset:3072 nt lds
    s_add_u32 s41, s29, 0
    s_add_u32 m0, s39, 65536
    s_nop 0
    buffer_load_dwordx4 v5, s[24:27], s41 offen offset:0 nt lds
    buffer_load_dwordx4 v5, s[24:27], s41 offen offset:1024 nt lds
    buffer_load_dwordx4 v5, s[24:27], s41 offen offset:2048 nt lds
    buffer_load_dwordx4 v5, s[24:27], s41 offen offset:3072 nt lds
    s_mov_b32 s8, s58
    s_mov_b32 s9, s59
    s_mov_b32 s10, 33554432
    s_mov_b32 s11, 0x20000
    s_mov_b32 s12, s60
    s_mov_b32 s13, s61
    s_mov_b32 s14, 33554432
    s_mov_b32 s15, 0x20000
    s_mov_b32 s16, s62
    s_mov_b32 s17, s63
    s_mov_b32 s18, 65011712
    s_mov_b32 s19, 0x20000
    s_mov_b32 s72, s62
    s_mov_b32 s73, s63
    s_mov_b32 s75, 0x20000
    s_mov_b32 s32, 0
    s_mov_b32 s33, 0
    v_sub_u32 v30, 0, v26
    v_and_b32 v30, 3, v30
    v_xor_b32 v30, v30, v23
    v_lshlrev_b32 v30, 4, v30
    v_lshl_add_u32 v30, v27, 6, v30
    v_lshl_add_u32 v1, v26, 10, v30
    v_add_u32 v9, s66, v1
    v_lshlrev_b32 v30, 10, v23
    v_lshl_add_u32 v30, v26, 6, v30
    v_lshl_add_u32 v30, v27, 4, v30
    v_add_u32 v2, 65536, v30

    v_and_b32 v30, 7, v21
    v_xor_b32 v31, v30, v23
    v_lshlrev_b32 v31, 4, v31
    v_lshl_add_u32 v31, v22, 7, v31
    v_add_u32 v12, s66, v31
    v_xor_b32 v13, 64, v12
    v_lshlrev_b32 v31, 4, v21
    v_add_u32 v11, s66, v31
    v_lshrrev_b32 v31, 3, v21
    v_xor_b32 v30, v30, v31
    v_lshlrev_b32 v30, 4, v30
    v_lshl_add_u32 v3, v31, 8, v30
    v_add_u32 v4, s46, v3
    v_mov_b32 v30, s47
    v_cmp_lt_u32 vcc, 31, v21
    v_mov_b32 v31, 0x3f803f80
    s_mov_b32 s34, 0x3e0293ee
    v_cndmask_b32 v10, 0, v30, vcc
    s_mov_b32 s35, 0xbe0293ee
    s_mov_b32 s36, 0x5f800000
    s_mov_b32 s37, -1
    s_mov_b32 s38, 0
    s_mov_b64 s[48:49], 0
    s_mov_b64 s[50:51], 0
    s_mov_b64 s[52:53], 0
    s_mov_b64 s[54:55], 0
    v_accvgpr_write_b32 a208, v31
    v_accvgpr_write_b32 a209, v31
    v_accvgpr_write_b32 a210, v31
    v_accvgpr_write_b32 a211, v31
    v_add_u32 v36, s39, v1
    v_add_u32 v37, 65536, v36
    v_and_b32 v30, 1, v21
    v_lshlrev_b32 v30, 4, v30
    v_mov_b32 v31, 15875
    v_mov_b32 v28, 47576
    v_lshlrev_b32 v31, v30, v31
    v_lshlrev_b32 v28, v30, v28
    v_lshrrev_b32 v30, 1, v22
    v_lshlrev_b32 v29, 1, v23
    v_cmp_eq_u32 vcc, v30, v29
    v_add_u32 v29, 1, v29
    v_accvgpr_write_b32 a244, 0
    v_cndmask_b32 v24, 0, v31, vcc
    v_cndmask_b32 v25, 0, v28, vcc
    v_cmp_eq_u32 vcc, v30, v29
    v_accvgpr_write_b32 a246, v24
    v_accvgpr_write_b32 a250, v25
    v_cndmask_b32 v24, 0, v31, vcc
    v_cndmask_b32 v25, 0, v28, vcc
    v_accvgpr_write_b32 a245, 0
    v_accvgpr_write_b32 a248, 0
    v_accvgpr_write_b32 a249, 0
    v_accvgpr_write_b32 a252, 0
    v_accvgpr_write_b32 a253, 0
    v_accvgpr_write_b32 a247, v24
    v_accvgpr_write_b32 a251, v25
    s_mov_b32 s56, s31
    s_mov_b32 s57, s64
    s_mov_b32 s58, s65
    s_or_b64 s[48:49], s[48:49], s[50:51]
    s_or_b64 s[52:53], s[52:53], s[54:55]
    s_or_b64 s[48:49], s[48:49], s[52:53]
    s_cselect_b32 s42, 1, 0
    s_lshl_b32 s42, s42, s37
    s_or_b32 s38, s38, s42
    s_mov_b64 s[76:77], s[32:33]
    s_mov_b64 s[32:33], s[30:31]
    s_mov_b32 s28, s29
    s_add_u32 s37, s37, 1
    s_cselect_b32 s74, 0, 65011712
    s_cmp_lt_u32 s37, 3
    s_cselect_b32 s42, 253952, 0
    s_cselect_b32 s45, 131072, 0
    s_cselect_b32 s6, s6, 0
    s_cselect_b32 s70, s70, 0
    s_cselect_b32 s22, s22, 0
    s_cselect_b32 s26, s26, 0
    s_add_u32 s30, s30, s42
    s_add_u32 s31, s31, s42
    s_add_u32 s64, s64, s42
    s_add_u32 s65, s65, s42
    s_add_u32 s29, s29, s45
    s_waitcnt vmcnt(12)
    s_barrier
    ds_read_b128 a[128:131], v1 offset:0
    ds_read_b128 a[132:135], v1 offset:256
    ds_read_b128 a[136:139], v1 offset:512
    ds_read_b128 a[140:143], v1 offset:768
    ds_read_b128 a[144:147], v1 offset:4096
    ds_read_b128 a[148:151], v1 offset:4352
    ds_read_b128 a[152:155], v1 offset:4608
    ds_read_b128 a[156:159], v1 offset:4864
    ds_read_b128 a[160:163], v1 offset:8192
    ds_read_b128 a[164:167], v1 offset:8448
    ds_read_b128 a[168:171], v1 offset:8704
    ds_read_b128 a[172:175], v1 offset:8960
    ds_read_b128 a[176:179], v1 offset:12288
    ds_read_b128 a[180:183], v1 offset:12544
    ds_read_b128 a[184:187], v1 offset:12800
    ds_read_b128 a[188:191], v1 offset:13056
    s_add_u32 m0, s66, 4096
    s_nop 0
    buffer_load_dwordx4 v5, s[4:7], s56 offen offset:0 nt lds
    buffer_load_dwordx4 v6, s[4:7], s56 offen offset:1024 nt lds
    buffer_load_dwordx4 v7, s[4:7], s56 offen offset:2048 nt lds
    buffer_load_dwordx4 v8, s[4:7], s56 offen offset:3072 nt lds
    s_waitcnt vmcnt(12)
    ds_read_b128 a[0:3], v9 offset:0
    ds_read_b128 a[4:7], v9 offset:256
    ds_read_b128 a[8:11], v9 offset:512
    ds_read_b128 a[12:15], v9 offset:768
    s_add_u32 m0, s39, 114688
    s_nop 0
    buffer_load_dwordx4 v5, s[68:71], s57 offen offset:0 nt lds
    buffer_load_dwordx4 v6, s[68:71], s57 offen offset:1024 nt lds
    buffer_load_dwordx4 v7, s[68:71], s57 offen offset:2048 nt lds
    buffer_load_dwordx4 v8, s[68:71], s57 offen offset:3072 nt lds
    s_waitcnt lgkmcnt(0)
    v_mfma_f32_16x16x32_bf16 v[128:131], a[128:131], a[0:3], 0
    v_mfma_f32_16x16x32_bf16 v[128:131], a[132:135], a[4:7], v[128:131]
    v_mfma_f32_16x16x32_bf16 v[128:131], a[136:139], a[8:11], v[128:131]
    v_mfma_f32_16x16x32_bf16 v[128:131], a[140:143], a[12:15], v[128:131]
    s_nop 0
    s_nop 0
    s_nop 0
    v_mfma_f32_16x16x32_bf16 v[144:147], a[144:147], a[0:3], 0
    s_nop 0
    s_nop 0
    s_nop 0
    v_mfma_f32_16x16x32_bf16 v[144:147], a[148:151], a[4:7], v[144:147]
    v_max3_f32 v21, v128, v129, v130
    v_max_f32 v21, v21, v131
    v_mfma_f32_16x16x32_bf16 v[144:147], a[152:155], a[8:11], v[144:147]
    v_mov_b32 v22, v21
    s_nop 0
    v_mfma_f32_16x16x32_bf16 v[144:147], a[156:159], a[12:15], v[144:147]
    v_permlane16_swap_b32 v21, v22
    v_mfma_f32_16x16x32_bf16 v[160:163], a[160:163], a[0:3], 0
    v_max_f32 v21, v21, v22
    v_mov_b32 v22, v21
    v_mfma_f32_16x16x32_bf16 v[160:163], a[164:167], a[4:7], v[160:163]
    s_nop 0
    v_permlane32_swap_b32 v21, v22
    v_mfma_f32_16x16x32_bf16 v[160:163], a[168:171], a[8:11], v[160:163]
    v_max_f32 v21, v21, v22
    v_mul_f32 v20, s35, v21
    v_mfma_f32_16x16x32_bf16 v[160:163], a[172:175], a[12:15], v[160:163]
    v_fma_f32 v128, v128, s34, v20
    v_fma_f32 v129, v129, s34, v20
    v_fma_f32 v130, v130, s34, v20
    v_fma_f32 v131, v131, s34, v20
    v_fma_f32 v144, v144, s34, v20
    v_fma_f32 v145, v145, s34, v20
    v_fma_f32 v146, v146, s34, v20
    v_fma_f32 v147, v147, s34, v20
    v_fma_f32 v160, v160, s34, v20
    v_fma_f32 v161, v161, s34, v20
    v_fma_f32 v162, v162, s34, v20
    v_fma_f32 v163, v163, s34, v20
    v_exp_f32 v128, v128
    v_exp_f32 v129, v129
    v_exp_f32 v130, v130
    v_exp_f32 v131, v131
    v_exp_f32 v144, v144
    v_mfma_f32_16x16x32_bf16 v[176:179], a[176:179], a[0:3], 0
    v_exp_f32 v145, v145
    v_mfma_f32_16x16x32_bf16 v[176:179], a[180:183], a[4:7], v[176:179]
    v_exp_f32 v146, v146
    v_mfma_f32_16x16x32_bf16 v[176:179], a[184:187], a[8:11], v[176:179]
    v_exp_f32 v147, v147
    v_mfma_f32_16x16x32_bf16 v[176:179], a[188:191], a[12:15], v[176:179]
    v_exp_f32 v160, v160
    v_exp_f32 v161, v161
    v_exp_f32 v162, v162
    v_mfma_f32_16x16x32_bf16 v[224:227], a[246:249], a[0:3], 0
    v_exp_f32 v163, v163
    v_mfma_f32_16x16x32_bf16 v[224:227], a[250:253], a[0:3], v[224:227]
    v_cvt_pk_bf16_f32 v64, v128, v129
    v_cvt_pk_bf16_f32 v65, v130, v131
    v_fma_f32 v176, v176, s34, v20
    v_fma_f32 v177, v177, s34, v20
    v_fma_f32 v178, v178, s34, v20
    v_mfma_f32_16x16x32_bf16 v[228:231], a[244:247], a[0:3], 0
    v_fma_f32 v179, v179, s34, v20
    v_cvt_pk_bf16_f32 v66, v144, v145
    v_mfma_f32_16x16x32_bf16 v[228:231], a[248:251], a[0:3], v[228:231]
    v_cvt_pk_bf16_f32 v224, v224, v225
    v_cvt_pk_bf16_f32 v226, v226, v227
    v_accvgpr_write_b32 a0, v224
    v_accvgpr_write_b32 a1, v226
    v_exp_f32 v176, v176
    v_mfma_f32_16x16x32_bf16 v[232:235], a[246:249], a[4:7], 0
    v_exp_f32 v177, v177
    v_mfma_f32_16x16x32_bf16 v[232:235], a[250:253], a[4:7], v[232:235]
    v_cvt_pk_bf16_f32 v228, v228, v229
    v_cvt_pk_bf16_f32 v230, v230, v231
    v_accvgpr_write_b32 a2, v228
    v_accvgpr_write_b32 a3, v230
    v_exp_f32 v178, v178
    v_mfma_f32_16x16x32_bf16 v[236:239], a[244:247], a[4:7], 0
    v_exp_f32 v179, v179
    v_mfma_f32_16x16x32_bf16 v[236:239], a[248:251], a[4:7], v[236:239]
    v_cvt_pk_bf16_f32 v232, v232, v233
    v_cvt_pk_bf16_f32 v234, v234, v235
    v_accvgpr_write_b32 a4, v232
    v_accvgpr_write_b32 a5, v234
    v_mfma_f32_16x16x32_bf16 v[224:227], a[246:249], a[8:11], 0
    v_cvt_pk_bf16_f32 v67, v146, v147
    v_cvt_pk_bf16_f32 v80, v160, v161
    v_mfma_f32_16x16x32_bf16 v[224:227], a[250:253], a[8:11], v[224:227]
    v_cvt_pk_bf16_f32 v236, v236, v237
    v_cvt_pk_bf16_f32 v238, v238, v239
    v_accvgpr_write_b32 a6, v236
    v_accvgpr_write_b32 a7, v238
    v_mfma_f32_16x16x32_bf16 v[228:231], a[244:247], a[8:11], 0
    v_cvt_pk_bf16_f32 v81, v162, v163
    v_cvt_pk_bf16_f32 v82, v176, v177
    v_mfma_f32_16x16x32_bf16 v[228:231], a[248:251], a[8:11], v[228:231]
    v_cvt_pk_bf16_f32 v224, v224, v225
    v_cvt_pk_bf16_f32 v226, v226, v227
    v_mfma_f32_16x16x32_bf16 v[232:235], a[246:249], a[12:15], 0
    v_accvgpr_write_b32 a8, v224
    v_accvgpr_write_b32 a9, v226
    v_mfma_f32_16x16x32_bf16 v[232:235], a[250:253], a[12:15], v[232:235]
    v_cvt_pk_bf16_f32 v83, v178, v179
    v_mov_b32 v21, v20
    v_mfma_f32_16x16x32_bf16 v[236:239], a[244:247], a[12:15], 0
    v_cvt_pk_bf16_f32 v228, v228, v229
    v_cvt_pk_bf16_f32 v230, v230, v231
    v_mfma_f32_16x16x32_bf16 v[236:239], a[248:251], a[12:15], v[236:239]
    v_accvgpr_write_b32 a10, v228
    v_accvgpr_write_b32 a11, v230
    v_cvt_pk_bf16_f32 v232, v232, v233
    v_cvt_pk_bf16_f32 v234, v234, v235
    v_accvgpr_write_b32 a12, v232
    v_accvgpr_write_b32 a13, v234
    v_mov_b32 v22, v20
    v_mov_b32 v23, v20
    v_cvt_pk_bf16_f32 v236, v236, v237
    v_cvt_pk_bf16_f32 v238, v238, v239
    v_accvgpr_write_b32 a14, v236
    v_accvgpr_write_b32 a15, v238
    s_waitcnt vmcnt(8)
    s_add_u32 m0, s66, 0
    s_nop 0
    buffer_load_dwordx4 v5, s[68:71], s58 offen offset:0 nt lds
    buffer_load_dwordx4 v6, s[68:71], s58 offen offset:1024 nt lds
    buffer_load_dwordx4 v7, s[68:71], s58 offen offset:2048 nt lds
    buffer_load_dwordx4 v8, s[68:71], s58 offen offset:3072 nt lds
    s_barrier
    ds_read_b128 a[64:67], v1 offset:16384
    ds_read_b128 a[68:71], v1 offset:16640
    ds_read_b128 a[72:75], v1 offset:16896
    ds_read_b128 a[76:79], v1 offset:17152
    s_waitcnt lgkmcnt(0)
    v_mfma_f32_16x16x32_bf16 v[192:195], a[64:67], a[0:3], v[20:23]
    ds_read_b128 a[80:83], v1 offset:20480
    ds_read_b128 a[84:87], v1 offset:20736
    v_mfma_f32_16x16x32_bf16 v[192:195], a[68:71], a[4:7], v[192:195]
    ds_read_b128 a[88:91], v1 offset:20992
    ds_read_b128 a[92:95], v1 offset:21248
    v_mfma_f32_16x16x32_bf16 v[192:195], a[72:75], a[8:11], v[192:195]
    ds_read_b128 a[96:99], v1 offset:24576
    ds_read_b128 a[100:103], v1 offset:24832
    v_mfma_f32_16x16x32_bf16 v[192:195], a[76:79], a[12:15], v[192:195]
    s_waitcnt lgkmcnt(2)
    ds_read_b128 a[104:107], v1 offset:25088
    ds_read_b128 a[108:111], v1 offset:25344
    v_mfma_f32_16x16x32_bf16 v[208:211], a[80:83], a[0:3], v[20:23]
    ds_read_b64_tr_b16 a[212:213], v2 offset:0
    ds_read_b64_tr_b16 a[214:215], v2 offset:4096
    v_mfma_f32_16x16x32_bf16 v[208:211], a[84:87], a[4:7], v[208:211]
    ds_read_b64_tr_b16 a[216:217], v2 offset:8192
    ds_read_b64_tr_b16 a[218:219], v2 offset:12288
    v_mfma_f32_16x16x32_bf16 v[208:211], a[88:91], a[8:11], v[208:211]
    ds_read_b64_tr_b16 a[220:221], v2 offset:8
    ds_read_b64_tr_b16 a[222:223], v2 offset:4104
    v_mfma_f32_16x16x32_bf16 v[208:211], a[92:95], a[12:15], v[208:211]
    s_waitcnt lgkmcnt(6)
    ds_read_b64_tr_b16 a[224:225], v2 offset:8200
    ds_read_b64_tr_b16 a[226:227], v2 offset:12296
    v_exp_f32 v192, v192
    v_mfma_f32_16x16x32_bf16 v[40:43], a[96:99], a[0:3], v[20:23]
    s_add_u32 s40, s28, 32768
    ds_read_b64_tr_b16 a[228:229], v2 offset:256
    ds_read_b64_tr_b16 a[230:231], v2 offset:4352
    v_mfma_f32_16x16x32_bf16 v[40:43], a[100:103], a[4:7], v[40:43]
    s_add_u32 m0, s39, 32768
    ds_read_b64_tr_b16 a[232:233], v2 offset:8448
    ds_read_b64_tr_b16 a[234:235], v2 offset:12544
    v_mfma_f32_16x16x32_bf16 v[40:43], a[104:107], a[8:11], v[40:43]
    ds_read_b64_tr_b16 a[236:237], v2 offset:264
    ds_read_b64_tr_b16 a[238:239], v2 offset:4360
    v_mfma_f32_16x16x32_bf16 v[40:43], a[108:111], a[12:15], v[40:43]
    s_waitcnt lgkmcnt(6)
    ds_read_b64_tr_b16 a[240:241], v2 offset:8456
    ds_read_b64_tr_b16 a[242:243], v2 offset:12552
    v_exp_f32 v193, v193
    v_exp_f32 v194, v194
    v_exp_f32 v195, v195
    v_cvt_pk_bf16_f32 v96, v192, v193
    v_cvt_pk_bf16_f32 v97, v194, v195
    v_mfma_f32_16x16x32_bf16 v[128:131], a[212:215], v[64:67], 0
    ds_read_b128 a[112:115], v1 offset:28672
    ds_read_b128 a[116:119], v1 offset:28928
    v_mfma_f32_16x16x32_bf16 v[128:131], a[216:219], v[80:83], v[128:131]
    buffer_load_dwordx4 v5, s[8:11], s40 offen offset:0 nt lds
    v_exp_f32 v40, v40
    v_mfma_f32_16x16x32_bf16 v[144:147], a[220:223], v[64:67], 0
    ds_read_b128 a[120:123], v1 offset:29184
    ds_read_b128 a[124:127], v1 offset:29440
    v_mfma_f32_16x16x32_bf16 v[144:147], a[224:227], v[80:83], v[144:147]
    s_waitcnt lgkmcnt(4)
    ds_read_b64_tr_b16 v[240:241], v2 offset:512
    ds_read_b64_tr_b16 v[242:243], v2 offset:4608
    v_exp_f32 v41, v41
    v_mfma_f32_16x16x32_bf16 v[160:163], a[228:231], v[64:67], 0
    ds_read_b64_tr_b16 v[244:245], v2 offset:8704
    ds_read_b64_tr_b16 v[246:247], v2 offset:12800
    v_mfma_f32_16x16x32_bf16 v[160:163], a[232:235], v[80:83], v[160:163]
    buffer_load_dwordx4 v6, s[8:11], s40 offen offset:1024 nt lds
    v_mfma_f32_16x16x32_bf16 v[176:179], a[236:239], v[64:67], 0
    ds_read_b64_tr_b16 v[248:249], v2 offset:520
    ds_read_b64_tr_b16 v[250:251], v2 offset:4616
    v_mfma_f32_16x16x32_bf16 v[176:179], a[240:243], v[80:83], v[176:179]
    s_waitcnt lgkmcnt(6)
    ds_read_b64_tr_b16 v[252:253], v2 offset:8712
    ds_read_b64_tr_b16 v[254:255], v2 offset:12808
    v_exp_f32 v42, v42
    v_exp_f32 v43, v43
    v_cvt_pk_bf16_f32 v112, v40, v41
    v_cvt_pk_bf16_f32 v113, v42, v43
    v_mfma_f32_16x16x32_bf16 v[40:43], a[112:115], a[0:3], v[20:23]
    v_exp_f32 v208, v208
    v_mfma_f32_16x16x32_bf16 v[40:43], a[116:119], a[4:7], v[40:43]
    v_exp_f32 v209, v209
    v_mfma_f32_16x16x32_bf16 v[40:43], a[120:123], a[8:11], v[40:43]
    v_exp_f32 v210, v210
    v_mfma_f32_16x16x32_bf16 v[40:43], a[124:127], a[12:15], v[40:43]
    buffer_load_dwordx4 v7, s[8:11], s40 offen offset:2048 nt lds
    v_mfma_f32_16x16x32_bf16 a[192:195], a[208:211], v[64:67], 0
    v_exp_f32 v211, v211
    v_mfma_f32_16x16x32_bf16 a[192:195], a[208:211], v[80:83], a[192:195]
    s_waitcnt lgkmcnt(0)
    buffer_load_dwordx4 v8, s[8:11], s40 offen offset:3072 nt lds
    v_mfma_f32_16x16x32_bf16 v[192:195], v[240:243], v[64:67], 0
    v_cvt_pk_bf16_f32 v98, v208, v209
    v_cvt_pk_bf16_f32 v99, v210, v211
    v_mfma_f32_16x16x32_bf16 v[192:195], v[244:247], v[80:83], v[192:195]
    v_exp_f32 v40, v40
    v_exp_f32 v41, v41
    v_mfma_f32_16x16x32_bf16 v[208:211], v[248:251], v[64:67], 0
    v_exp_f32 v42, v42
    v_mfma_f32_16x16x32_bf16 v[208:211], v[252:255], v[80:83], v[208:211]
    v_exp_f32 v43, v43
    v_cvt_pk_bf16_f32 v114, v40, v41
    v_cvt_pk_bf16_f32 v115, v42, v43
    s_waitcnt vmcnt(12)
    ds_read_b128 a[16:19], v9 offset:4096
    ds_read_b128 a[20:23], v9 offset:4352
    ds_read_b128 a[24:27], v9 offset:4608
    ds_read_b128 a[28:31], v9 offset:4864
    s_add_u32 s41, s28, 16384
    s_add_u32 m0, s39, 81920
    s_nop 0
    buffer_load_dwordx4 v5, s[12:15], s41 offen offset:0 nt lds
    buffer_load_dwordx4 v5, s[12:15], s41 offen offset:1024 nt lds
    buffer_load_dwordx4 v5, s[12:15], s41 offen offset:2048 nt lds
    buffer_load_dwordx4 v5, s[12:15], s41 offen offset:3072 nt lds
    s_waitcnt lgkmcnt(0)
    v_mfma_f32_16x16x32_bf16 v[132:135], a[128:131], a[16:19], 0
    v_mfma_f32_16x16x32_bf16 v[132:135], a[132:135], a[20:23], v[132:135]
    v_mfma_f32_16x16x32_bf16 v[132:135], a[136:139], a[24:27], v[132:135]
    v_mfma_f32_16x16x32_bf16 v[132:135], a[140:143], a[28:31], v[132:135]
    s_nop 0
    s_nop 0
    s_nop 0
    v_mfma_f32_16x16x32_bf16 v[148:151], a[144:147], a[16:19], 0
    s_nop 0
    s_nop 0
    s_nop 0
    v_mfma_f32_16x16x32_bf16 v[148:151], a[148:151], a[20:23], v[148:151]
    v_max3_f32 v25, v132, v133, v134
    v_max_f32 v25, v25, v135
    v_mfma_f32_16x16x32_bf16 v[148:151], a[152:155], a[24:27], v[148:151]
    v_mov_b32 v26, v25
    s_nop 0
    v_mfma_f32_16x16x32_bf16 v[148:151], a[156:159], a[28:31], v[148:151]
    v_permlane16_swap_b32 v25, v26
    v_mfma_f32_16x16x32_bf16 v[164:167], a[160:163], a[16:19], 0
    v_max_f32 v25, v25, v26
    v_mov_b32 v26, v25
    v_mfma_f32_16x16x32_bf16 v[164:167], a[164:167], a[20:23], v[164:167]
    s_nop 0
    v_permlane32_swap_b32 v25, v26
    v_mfma_f32_16x16x32_bf16 v[164:167], a[168:171], a[24:27], v[164:167]
    v_max_f32 v25, v25, v26
    v_mul_f32 v24, s35, v25
    v_mfma_f32_16x16x32_bf16 v[164:167], a[172:175], a[28:31], v[164:167]
    v_mov_b32 v25, v24
    v_mov_b32 v26, v24
    v_mov_b32 v27, v24
    v_fma_f32 v132, v132, s34, v24
    v_mfma_f32_16x16x32_bf16 v[180:183], a[176:179], a[16:19], 0
    v_fma_f32 v133, v133, s34, v24
    v_fma_f32 v134, v134, s34, v24
    v_mfma_f32_16x16x32_bf16 v[180:183], a[180:183], a[20:23], v[180:183]
    v_fma_f32 v135, v135, s34, v24
    v_fma_f32 v148, v148, s34, v24
    v_mfma_f32_16x16x32_bf16 v[180:183], a[184:187], a[24:27], v[180:183]
    v_fma_f32 v149, v149, s34, v24
    v_fma_f32 v150, v150, s34, v24
    v_mfma_f32_16x16x32_bf16 v[180:183], a[188:191], a[28:31], v[180:183]
    v_fma_f32 v151, v151, s34, v24
    v_fma_f32 v164, v164, s34, v24
    v_exp_f32 v132, v132
    v_mfma_f32_16x16x32_bf16 v[224:227], a[246:249], a[16:19], 0
    v_exp_f32 v133, v133
    v_mfma_f32_16x16x32_bf16 v[224:227], a[250:253], a[16:19], v[224:227]
    v_exp_f32 v134, v134
    v_mfma_f32_16x16x32_bf16 v[228:231], a[244:247], a[16:19], 0
    v_exp_f32 v135, v135
    v_mfma_f32_16x16x32_bf16 v[228:231], a[248:251], a[16:19], v[228:231]
    v_exp_f32 v148, v148
    v_exp_f32 v149, v149
    v_mfma_f32_16x16x32_bf16 v[232:235], a[246:249], a[20:23], 0
    v_exp_f32 v150, v150
    v_mfma_f32_16x16x32_bf16 v[232:235], a[250:253], a[20:23], v[232:235]
    v_cvt_pk_bf16_f32 v224, v224, v225
    v_cvt_pk_bf16_f32 v226, v226, v227
    v_mfma_f32_16x16x32_bf16 v[236:239], a[244:247], a[20:23], 0
    v_accvgpr_write_b32 a16, v224
    v_accvgpr_write_b32 a17, v226
    v_mfma_f32_16x16x32_bf16 v[236:239], a[248:251], a[20:23], v[236:239]
    v_cvt_pk_bf16_f32 v228, v228, v229
    v_cvt_pk_bf16_f32 v230, v230, v231
    v_accvgpr_write_b32 a18, v228
    v_mfma_f32_16x16x32_bf16 v[224:227], a[246:249], a[24:27], 0
    v_accvgpr_write_b32 a19, v230
    v_cvt_pk_bf16_f32 v232, v232, v233
    v_mfma_f32_16x16x32_bf16 v[224:227], a[250:253], a[24:27], v[224:227]
    v_cvt_pk_bf16_f32 v234, v234, v235
    v_accvgpr_write_b32 a20, v232
    v_accvgpr_write_b32 a21, v234
    v_mfma_f32_16x16x32_bf16 v[228:231], a[244:247], a[24:27], 0
    v_cvt_pk_bf16_f32 v236, v236, v237
    v_cvt_pk_bf16_f32 v238, v238, v239
    v_mfma_f32_16x16x32_bf16 v[228:231], a[248:251], a[24:27], v[228:231]
    v_accvgpr_write_b32 a22, v236
    v_accvgpr_write_b32 a23, v238
    v_cvt_pk_bf16_f32 v224, v224, v225
    v_mfma_f32_16x16x32_bf16 v[232:235], a[246:249], a[28:31], 0
    v_cvt_pk_bf16_f32 v226, v226, v227
    v_accvgpr_write_b32 a24, v224
    v_mfma_f32_16x16x32_bf16 v[232:235], a[250:253], a[28:31], v[232:235]
    v_accvgpr_write_b32 a25, v226
    v_cvt_pk_bf16_f32 v228, v228, v229
    v_cvt_pk_bf16_f32 v230, v230, v231
    v_mfma_f32_16x16x32_bf16 v[236:239], a[244:247], a[28:31], 0
    v_accvgpr_write_b32 a26, v228
    v_accvgpr_write_b32 a27, v230
    v_mfma_f32_16x16x32_bf16 v[236:239], a[248:251], a[28:31], v[236:239]
    v_exp_f32 v151, v151
    v_cvt_pk_bf16_f32 v232, v232, v233
    v_cvt_pk_bf16_f32 v234, v234, v235
    v_mfma_f32_16x16x32_bf16 v[196:199], a[64:67], a[16:19], v[24:27]
    v_accvgpr_write_b32 a28, v232
    v_accvgpr_write_b32 a29, v234
    v_mfma_f32_16x16x32_bf16 v[196:199], a[68:71], a[20:23], v[196:199]
    v_cvt_pk_bf16_f32 v68, v132, v133
    v_cvt_pk_bf16_f32 v236, v236, v237
    v_mfma_f32_16x16x32_bf16 v[196:199], a[72:75], a[24:27], v[196:199]
    v_cvt_pk_bf16_f32 v238, v238, v239
    v_accvgpr_write_b32 a30, v236
    v_accvgpr_write_b32 a31, v238
    v_cvt_pk_bf16_f32 v69, v134, v135
    v_cvt_pk_bf16_f32 v70, v148, v149
    v_mfma_f32_16x16x32_bf16 v[196:199], a[76:79], a[28:31], v[196:199]
    v_cvt_pk_bf16_f32 v71, v150, v151
    v_fma_f32 v165, v165, s34, v24
    v_mfma_f32_16x16x32_bf16 v[212:215], a[80:83], a[16:19], v[24:27]
    v_fma_f32 v166, v166, s34, v24
    v_fma_f32 v167, v167, s34, v24
    v_mfma_f32_16x16x32_bf16 v[212:215], a[84:87], a[20:23], v[212:215]
    v_fma_f32 v180, v180, s34, v24
    v_fma_f32 v181, v181, s34, v24
    v_mfma_f32_16x16x32_bf16 v[212:215], a[88:91], a[24:27], v[212:215]
    v_fma_f32 v182, v182, s34, v24
    v_fma_f32 v183, v183, s34, v24
    v_mfma_f32_16x16x32_bf16 v[212:215], a[92:95], a[28:31], v[212:215]
    v_exp_f32 v164, v164
    v_exp_f32 v165, v165
    v_mfma_f32_16x16x32_bf16 v[44:47], a[96:99], a[16:19], v[24:27]
    v_exp_f32 v166, v166
    v_mfma_f32_16x16x32_bf16 v[44:47], a[100:103], a[20:23], v[44:47]
    v_exp_f32 v167, v167
    v_mfma_f32_16x16x32_bf16 v[44:47], a[104:107], a[24:27], v[44:47]
    v_exp_f32 v180, v180
    v_mfma_f32_16x16x32_bf16 v[44:47], a[108:111], a[28:31], v[44:47]
    v_exp_f32 v181, v181
    v_mfma_f32_16x16x32_bf16 v[132:135], a[212:215], v[68:71], 0
    v_exp_f32 v182, v182
    v_exp_f32 v183, v183
    v_cvt_pk_bf16_f32 v84, v164, v165
    v_cvt_pk_bf16_f32 v85, v166, v167
    v_cvt_pk_bf16_f32 v86, v180, v181
    v_cvt_pk_bf16_f32 v87, v182, v183
    v_exp_f32 v44, v44
    v_exp_f32 v45, v45
    v_mfma_f32_16x16x32_bf16 v[132:135], a[216:219], v[84:87], v[132:135]
    v_exp_f32 v46, v46
    v_mfma_f32_16x16x32_bf16 v[148:151], a[220:223], v[68:71], 0
    v_exp_f32 v47, v47
    v_mfma_f32_16x16x32_bf16 v[148:151], a[224:227], v[84:87], v[148:151]
    v_cvt_pk_bf16_f32 v116, v44, v45
    v_cvt_pk_bf16_f32 v117, v46, v47
    v_mfma_f32_16x16x32_bf16 v[164:167], a[228:231], v[68:71], 0
    v_exp_f32 v196, v196
    v_mfma_f32_16x16x32_bf16 v[164:167], a[232:235], v[84:87], v[164:167]
    v_exp_f32 v197, v197
    v_mfma_f32_16x16x32_bf16 v[180:183], a[236:239], v[68:71], 0
    v_exp_f32 v198, v198
    v_mfma_f32_16x16x32_bf16 v[180:183], a[240:243], v[84:87], v[180:183]
    v_exp_f32 v199, v199
    v_mfma_f32_16x16x32_bf16 v[44:47], a[112:115], a[16:19], v[24:27]
    v_cvt_pk_bf16_f32 v100, v196, v197
    v_cvt_pk_bf16_f32 v101, v198, v199
    v_mfma_f32_16x16x32_bf16 v[44:47], a[116:119], a[20:23], v[44:47]
    v_exp_f32 v212, v212
    v_mfma_f32_16x16x32_bf16 v[44:47], a[120:123], a[24:27], v[44:47]
    v_exp_f32 v213, v213
    v_mfma_f32_16x16x32_bf16 v[44:47], a[124:127], a[28:31], v[44:47]
    v_exp_f32 v214, v214
    v_mfma_f32_16x16x32_bf16 a[196:199], a[208:211], v[68:71], 0
    v_exp_f32 v215, v215
    v_mfma_f32_16x16x32_bf16 a[196:199], a[208:211], v[84:87], a[196:199]
    v_cvt_pk_bf16_f32 v102, v212, v213
    v_cvt_pk_bf16_f32 v103, v214, v215
    v_mfma_f32_16x16x32_bf16 v[196:199], v[240:243], v[68:71], 0
    v_mfma_f32_16x16x32_bf16 v[196:199], v[244:247], v[84:87], v[196:199]
    v_exp_f32 v44, v44
    v_mfma_f32_16x16x32_bf16 v[212:215], v[248:251], v[68:71], 0
    v_exp_f32 v45, v45
    v_mfma_f32_16x16x32_bf16 v[212:215], v[252:255], v[84:87], v[212:215]
    v_exp_f32 v46, v46
    s_waitcnt vmcnt(12)
    ds_read_b128 a[32:35], v37 offset:49152
    ds_read_b128 a[36:39], v37 offset:49408
    ds_read_b128 a[40:43], v37 offset:49664
    ds_read_b128 a[44:47], v37 offset:49920
    s_add_u32 s40, s28, 49152
    s_add_u32 m0, s39, 49152
    s_nop 0
    buffer_load_dwordx4 v5, s[8:11], s40 offen offset:0 nt lds
    buffer_load_dwordx4 v6, s[8:11], s40 offen offset:1024 nt lds
    buffer_load_dwordx4 v7, s[8:11], s40 offen offset:2048 nt lds
    buffer_load_dwordx4 v8, s[8:11], s40 offen offset:3072 nt lds
    s_waitcnt lgkmcnt(0)
    v_mfma_f32_16x16x32_bf16 v[136:139], a[128:131], a[32:35], 0
    v_mfma_f32_16x16x32_bf16 v[136:139], a[132:135], a[36:39], v[136:139]
    v_mfma_f32_16x16x32_bf16 v[136:139], a[136:139], a[40:43], v[136:139]
    v_mfma_f32_16x16x32_bf16 v[136:139], a[140:143], a[44:47], v[136:139]
    s_nop 0
    s_nop 0
    s_nop 0
    v_mfma_f32_16x16x32_bf16 v[152:155], a[144:147], a[32:35], 0
    s_nop 0
    s_nop 0
    s_nop 0
    v_mfma_f32_16x16x32_bf16 v[152:155], a[148:151], a[36:39], v[152:155]
    v_max3_f32 v29, v136, v137, v138
    v_max_f32 v29, v29, v139
    v_mfma_f32_16x16x32_bf16 v[152:155], a[152:155], a[40:43], v[152:155]
    v_mov_b32 v30, v29
    s_nop 0
    v_mfma_f32_16x16x32_bf16 v[152:155], a[156:159], a[44:47], v[152:155]
    v_permlane16_swap_b32 v29, v30
    v_mfma_f32_16x16x32_bf16 v[168:171], a[160:163], a[32:35], 0
    v_max_f32 v29, v29, v30
    v_mov_b32 v30, v29
    v_mfma_f32_16x16x32_bf16 v[168:171], a[164:167], a[36:39], v[168:171]
    s_nop 0
    v_permlane32_swap_b32 v29, v30
    v_mfma_f32_16x16x32_bf16 v[168:171], a[168:171], a[40:43], v[168:171]
    v_max_f32 v29, v29, v30
    v_mul_f32 v28, s35, v29
    v_mfma_f32_16x16x32_bf16 v[168:171], a[172:175], a[44:47], v[168:171]
    v_add_f32 v28, s47, v28
    v_mov_b32 v29, v28
    v_mov_b32 v30, v28
    v_mfma_f32_16x16x32_bf16 v[184:187], a[176:179], a[32:35], 0
    v_mov_b32 v31, v28
    v_fma_f32 v136, v136, s34, v28
    v_mfma_f32_16x16x32_bf16 v[184:187], a[180:183], a[36:39], v[184:187]
    v_fma_f32 v137, v137, s34, v28
    v_fma_f32 v138, v138, s34, v28
    v_mfma_f32_16x16x32_bf16 v[184:187], a[184:187], a[40:43], v[184:187]
    v_fma_f32 v139, v139, s34, v28
    v_fma_f32 v152, v152, s34, v28
    v_mfma_f32_16x16x32_bf16 v[184:187], a[188:191], a[44:47], v[184:187]
    v_fma_f32 v153, v153, s34, v28
    v_fma_f32 v154, v154, s34, v28
    v_fma_f32 v155, v155, s34, v28
    v_mfma_f32_16x16x32_bf16 v[224:227], a[246:249], a[32:35], 0
    v_exp_f32 v136, v136
    v_mfma_f32_16x16x32_bf16 v[224:227], a[250:253], a[32:35], v[224:227]
    v_exp_f32 v137, v137
    v_exp_f32 v138, v138
    v_mfma_f32_16x16x32_bf16 v[228:231], a[244:247], a[32:35], 0
    v_exp_f32 v139, v139
    v_mfma_f32_16x16x32_bf16 v[228:231], a[248:251], a[32:35], v[228:231]
    v_exp_f32 v152, v152
    v_mfma_f32_16x16x32_bf16 v[232:235], a[246:249], a[36:39], 0
    v_exp_f32 v153, v153
    v_mfma_f32_16x16x32_bf16 v[232:235], a[250:253], a[36:39], v[232:235]
    v_cvt_pk_bf16_f32 v224, v224, v225
    v_cvt_pk_bf16_f32 v226, v226, v227
    v_mfma_f32_16x16x32_bf16 v[236:239], a[244:247], a[36:39], 0
    v_accvgpr_write_b32 a32, v224
    v_accvgpr_write_b32 a33, v226
    v_mfma_f32_16x16x32_bf16 v[236:239], a[248:251], a[36:39], v[236:239]
    v_cvt_pk_bf16_f32 v228, v228, v229
    v_cvt_pk_bf16_f32 v230, v230, v231
    v_accvgpr_write_b32 a34, v228
    v_mfma_f32_16x16x32_bf16 v[224:227], a[246:249], a[40:43], 0
    v_accvgpr_write_b32 a35, v230
    v_cvt_pk_bf16_f32 v232, v232, v233
    v_mfma_f32_16x16x32_bf16 v[224:227], a[250:253], a[40:43], v[224:227]
    v_cvt_pk_bf16_f32 v234, v234, v235
    v_accvgpr_write_b32 a36, v232
    v_accvgpr_write_b32 a37, v234
    v_mfma_f32_16x16x32_bf16 v[228:231], a[244:247], a[40:43], 0
    v_cvt_pk_bf16_f32 v236, v236, v237
    v_cvt_pk_bf16_f32 v238, v238, v239
    v_mfma_f32_16x16x32_bf16 v[228:231], a[248:251], a[40:43], v[228:231]
    v_accvgpr_write_b32 a38, v236
    v_accvgpr_write_b32 a39, v238
    v_cvt_pk_bf16_f32 v224, v224, v225
    v_mfma_f32_16x16x32_bf16 v[232:235], a[246:249], a[44:47], 0
    v_cvt_pk_bf16_f32 v226, v226, v227
    v_accvgpr_write_b32 a40, v224
    v_mfma_f32_16x16x32_bf16 v[232:235], a[250:253], a[44:47], v[232:235]
    v_accvgpr_write_b32 a41, v226
    v_cvt_pk_bf16_f32 v228, v228, v229
    v_mfma_f32_16x16x32_bf16 v[236:239], a[244:247], a[44:47], 0
    v_cvt_pk_bf16_f32 v230, v230, v231
    v_accvgpr_write_b32 a42, v228
    v_mfma_f32_16x16x32_bf16 v[236:239], a[248:251], a[44:47], v[236:239]
    v_accvgpr_write_b32 a43, v230
    v_cvt_pk_bf16_f32 v72, v136, v137
    v_cvt_pk_bf16_f32 v232, v232, v233
    v_cvt_pk_bf16_f32 v234, v234, v235
    v_mfma_f32_16x16x32_bf16 v[200:203], a[64:67], a[32:35], v[28:31]
    v_accvgpr_write_b32 a44, v232
    v_accvgpr_write_b32 a45, v234
    v_mfma_f32_16x16x32_bf16 v[200:203], a[68:71], a[36:39], v[200:203]
    v_cvt_pk_bf16_f32 v236, v236, v237
    v_cvt_pk_bf16_f32 v238, v238, v239
    v_mfma_f32_16x16x32_bf16 v[200:203], a[72:75], a[40:43], v[200:203]
    v_accvgpr_write_b32 a46, v236
    v_accvgpr_write_b32 a47, v238
    v_exp_f32 v154, v154
    v_exp_f32 v155, v155
    v_mfma_f32_16x16x32_bf16 v[200:203], a[76:79], a[44:47], v[200:203]
    v_cvt_pk_bf16_f32 v73, v138, v139
    v_cvt_pk_bf16_f32 v74, v152, v153
    v_mfma_f32_16x16x32_bf16 v[216:219], a[80:83], a[32:35], v[28:31]
    v_cvt_pk_bf16_f32 v75, v154, v155
    v_fma_f32 v168, v168, s34, v28
    v_mfma_f32_16x16x32_bf16 v[216:219], a[84:87], a[36:39], v[216:219]
    v_fma_f32 v169, v169, s34, v28
    v_fma_f32 v170, v170, s34, v28
    v_mfma_f32_16x16x32_bf16 v[216:219], a[88:91], a[40:43], v[216:219]
    v_fma_f32 v171, v171, s34, v28
    v_fma_f32 v184, v184, s34, v28
    v_mfma_f32_16x16x32_bf16 v[216:219], a[92:95], a[44:47], v[216:219]
    v_fma_f32 v185, v185, s34, v28
    v_fma_f32 v186, v186, s34, v28
    v_mfma_f32_16x16x32_bf16 v[48:51], a[96:99], a[32:35], v[28:31]
    v_exp_f32 v168, v168
    v_mfma_f32_16x16x32_bf16 v[48:51], a[100:103], a[36:39], v[48:51]
    v_exp_f32 v169, v169
    v_mfma_f32_16x16x32_bf16 v[48:51], a[104:107], a[40:43], v[48:51]
    v_fma_f32 v187, v187, s34, v28
    v_cvt_pk_bf16_f32 v88, v168, v169
    v_mfma_f32_16x16x32_bf16 v[48:51], a[108:111], a[44:47], v[48:51]
    v_exp_f32 v170, v170
    v_mfma_f32_16x16x32_bf16 v[136:139], a[212:215], v[72:75], 0
    v_exp_f32 v171, v171
    v_exp_f32 v184, v184
    v_exp_f32 v185, v185
    v_exp_f32 v186, v186
    v_exp_f32 v187, v187
    v_cvt_pk_bf16_f32 v89, v170, v171
    v_cvt_pk_bf16_f32 v90, v184, v185
    v_cvt_pk_bf16_f32 v91, v186, v187
    v_exp_f32 v200, v200
    v_exp_f32 v201, v201
    v_mfma_f32_16x16x32_bf16 v[136:139], a[216:219], v[88:91], v[136:139]
    v_exp_f32 v202, v202
    v_mfma_f32_16x16x32_bf16 v[152:155], a[220:223], v[72:75], 0
    v_exp_f32 v203, v203
    v_mfma_f32_16x16x32_bf16 v[152:155], a[224:227], v[88:91], v[152:155]
    v_cvt_pk_bf16_f32 v104, v200, v201
    v_cvt_pk_bf16_f32 v105, v202, v203
    v_mfma_f32_16x16x32_bf16 v[168:171], a[228:231], v[72:75], 0
    v_exp_f32 v216, v216
    v_mfma_f32_16x16x32_bf16 v[168:171], a[232:235], v[88:91], v[168:171]
    v_exp_f32 v217, v217
    v_mfma_f32_16x16x32_bf16 v[184:187], a[236:239], v[72:75], 0
    v_exp_f32 v218, v218
    v_mfma_f32_16x16x32_bf16 v[184:187], a[240:243], v[88:91], v[184:187]
    v_exp_f32 v219, v219
    v_mfma_f32_16x16x32_bf16 v[52:55], a[112:115], a[32:35], v[28:31]
    v_cvt_pk_bf16_f32 v106, v216, v217
    v_cvt_pk_bf16_f32 v107, v218, v219
    v_mfma_f32_16x16x32_bf16 v[52:55], a[116:119], a[36:39], v[52:55]
    v_exp_f32 v48, v48
    v_mfma_f32_16x16x32_bf16 v[52:55], a[120:123], a[40:43], v[52:55]
    v_exp_f32 v49, v49
    v_mfma_f32_16x16x32_bf16 v[52:55], a[124:127], a[44:47], v[52:55]
    v_exp_f32 v50, v50
    v_mfma_f32_16x16x32_bf16 a[200:203], a[208:211], v[72:75], 0
    v_exp_f32 v51, v51
    v_mfma_f32_16x16x32_bf16 a[200:203], a[208:211], v[88:91], a[200:203]
    v_cvt_pk_bf16_f32 v120, v48, v49
    v_cvt_pk_bf16_f32 v121, v50, v51
    v_mfma_f32_16x16x32_bf16 v[200:203], v[240:243], v[72:75], 0
    v_mfma_f32_16x16x32_bf16 v[200:203], v[244:247], v[88:91], v[200:203]
    v_mfma_f32_16x16x32_bf16 v[216:219], v[248:251], v[72:75], 0
    v_mfma_f32_16x16x32_bf16 v[216:219], v[252:255], v[88:91], v[216:219]
    s_waitcnt vmcnt(12)
    ds_read_b128 a[48:51], v9 offset:0
    ds_read_b128 a[52:55], v9 offset:256
    ds_read_b128 a[56:59], v9 offset:512
    ds_read_b128 a[60:63], v9 offset:768
    s_add_u32 s41, s28, 32768
    s_add_u32 m0, s39, 98304
    s_nop 0
    buffer_load_dwordx4 v5, s[12:15], s41 offen offset:0 nt lds
    buffer_load_dwordx4 v5, s[12:15], s41 offen offset:1024 nt lds
    buffer_load_dwordx4 v5, s[12:15], s41 offen offset:2048 nt lds
    buffer_load_dwordx4 v5, s[12:15], s41 offen offset:3072 nt lds
    s_waitcnt lgkmcnt(0)
    v_mfma_f32_16x16x32_bf16 v[140:143], a[128:131], a[48:51], 0
    v_mfma_f32_16x16x32_bf16 v[140:143], a[132:135], a[52:55], v[140:143]
    v_mfma_f32_16x16x32_bf16 v[140:143], a[136:139], a[56:59], v[140:143]
    v_mfma_f32_16x16x32_bf16 v[140:143], a[140:143], a[60:63], v[140:143]
    s_nop 0
    s_nop 0
    s_nop 0
    v_mfma_f32_16x16x32_bf16 v[156:159], a[144:147], a[48:51], 0
    s_nop 0
    s_nop 0
    s_nop 0
    v_mfma_f32_16x16x32_bf16 v[156:159], a[148:151], a[52:55], v[156:159]
    v_max3_f32 v33, v140, v141, v142
    v_max_f32 v33, v33, v143
    v_mfma_f32_16x16x32_bf16 v[156:159], a[152:155], a[56:59], v[156:159]
    v_mov_b32 v34, v33
    s_nop 0
    v_mfma_f32_16x16x32_bf16 v[156:159], a[156:159], a[60:63], v[156:159]
    v_permlane16_swap_b32 v33, v34
    v_mfma_f32_16x16x32_bf16 v[172:175], a[160:163], a[48:51], 0
    v_max_f32 v33, v33, v34
    v_mov_b32 v34, v33
    v_mfma_f32_16x16x32_bf16 v[172:175], a[164:167], a[52:55], v[172:175]
    s_nop 0
    v_permlane32_swap_b32 v33, v34
    v_mfma_f32_16x16x32_bf16 v[172:175], a[168:171], a[56:59], v[172:175]
    v_max_f32 v33, v33, v34
    v_mul_f32 v32, s35, v33
    v_mfma_f32_16x16x32_bf16 v[172:175], a[172:175], a[60:63], v[172:175]
    v_add_f32 v32, s47, v32
    v_mov_b32 v33, v32
    v_mov_b32 v34, v32
    v_mov_b32 v35, v32
    v_fma_f32 v140, v140, s34, v32
    v_fma_f32 v141, v141, s34, v32
    v_fma_f32 v142, v142, s34, v32
    v_fma_f32 v143, v143, s34, v32
    v_fma_f32 v156, v156, s34, v32
    v_fma_f32 v157, v157, s34, v32
    v_fma_f32 v158, v158, s34, v32
    v_fma_f32 v159, v159, s34, v32
    v_exp_f32 v140, v140
    v_mfma_f32_16x16x32_bf16 v[188:191], a[176:179], a[48:51], 0
    v_exp_f32 v141, v141
    v_mfma_f32_16x16x32_bf16 v[188:191], a[180:183], a[52:55], v[188:191]
    v_exp_f32 v142, v142
    v_mfma_f32_16x16x32_bf16 v[188:191], a[184:187], a[56:59], v[188:191]
    v_exp_f32 v143, v143
    v_mfma_f32_16x16x32_bf16 v[188:191], a[188:191], a[60:63], v[188:191]
    v_exp_f32 v156, v156
    v_exp_f32 v157, v157
    v_mfma_f32_16x16x32_bf16 v[224:227], a[246:249], a[48:51], 0
    v_exp_f32 v158, v158
    v_mfma_f32_16x16x32_bf16 v[224:227], a[250:253], a[48:51], v[224:227]
    s_add_u32 s40, s28, 65536
    v_exp_f32 v159, v159
    v_cvt_pk_bf16_f32 v76, v140, v141
    v_mfma_f32_16x16x32_bf16 v[228:231], a[244:247], a[48:51], 0
    s_add_u32 m0, s39, 0
    v_cvt_pk_bf16_f32 v77, v142, v143
    v_cvt_pk_bf16_f32 v78, v156, v157
    v_mfma_f32_16x16x32_bf16 v[228:231], a[248:251], a[48:51], v[228:231]
    v_cvt_pk_bf16_f32 v224, v224, v225
    v_cvt_pk_bf16_f32 v226, v226, v227
    v_accvgpr_write_b32 a48, v224
    v_accvgpr_write_b32 a49, v226
    v_mfma_f32_16x16x32_bf16 v[232:235], a[246:249], a[52:55], 0
    v_cvt_pk_bf16_f32 v79, v158, v159
    v_fma_f32 v172, v172, s34, v32
    v_mfma_f32_16x16x32_bf16 v[232:235], a[250:253], a[52:55], v[232:235]
    v_cvt_pk_bf16_f32 v228, v228, v229
    v_cvt_pk_bf16_f32 v230, v230, v231
    v_accvgpr_write_b32 a50, v228
    v_accvgpr_write_b32 a51, v230
    v_fma_f32 v173, v173, s34, v32
    v_mfma_f32_16x16x32_bf16 v[236:239], a[244:247], a[52:55], 0
    v_fma_f32 v174, v174, s34, v32
    v_fma_f32 v175, v175, s34, v32
    v_mfma_f32_16x16x32_bf16 v[236:239], a[248:251], a[52:55], v[236:239]
    buffer_load_dwordx4 v5, s[8:11], s40 offen offset:0 nt lds
    v_cvt_pk_bf16_f32 v232, v232, v233
    v_mfma_f32_16x16x32_bf16 v[224:227], a[246:249], a[56:59], 0
    v_cvt_pk_bf16_f32 v234, v234, v235
    v_accvgpr_write_b32 a52, v232
    v_mfma_f32_16x16x32_bf16 v[224:227], a[250:253], a[56:59], v[224:227]
    v_accvgpr_write_b32 a53, v234
    v_fma_f32 v188, v188, s34, v32
    v_cvt_pk_bf16_f32 v236, v236, v237
    v_cvt_pk_bf16_f32 v238, v238, v239
    v_mfma_f32_16x16x32_bf16 v[228:231], a[244:247], a[56:59], 0
    v_accvgpr_write_b32 a54, v236
    v_accvgpr_write_b32 a55, v238
    v_mfma_f32_16x16x32_bf16 v[228:231], a[248:251], a[56:59], v[228:231]
    buffer_load_dwordx4 v6, s[8:11], s40 offen offset:1024 nt lds
    v_cvt_pk_bf16_f32 v224, v224, v225
    v_mfma_f32_16x16x32_bf16 v[232:235], a[246:249], a[60:63], 0
    v_cvt_pk_bf16_f32 v226, v226, v227
    v_accvgpr_write_b32 a56, v224
    v_mfma_f32_16x16x32_bf16 v[232:235], a[250:253], a[60:63], v[232:235]
    v_accvgpr_write_b32 a57, v226
    v_fma_f32 v189, v189, s34, v32
    v_cvt_pk_bf16_f32 v228, v228, v229
    v_cvt_pk_bf16_f32 v230, v230, v231
    v_mfma_f32_16x16x32_bf16 v[236:239], a[244:247], a[60:63], 0
    s_add_u32 s41, s28, 49152
    v_accvgpr_write_b32 a58, v228
    v_accvgpr_write_b32 a59, v230
    v_mfma_f32_16x16x32_bf16 v[236:239], a[248:251], a[60:63], v[236:239]
    buffer_load_dwordx4 v7, s[8:11], s40 offen offset:2048 nt lds
    v_cvt_pk_bf16_f32 v232, v232, v233
    v_cvt_pk_bf16_f32 v234, v234, v235
    v_accvgpr_write_b32 a60, v232
    v_mfma_f32_16x16x32_bf16 v[204:207], a[64:67], a[48:51], v[32:35]
    v_accvgpr_write_b32 a61, v234
    v_fma_f32 v190, v190, s34, v32
    v_mfma_f32_16x16x32_bf16 v[204:207], a[68:71], a[52:55], v[204:207]
    v_cvt_pk_bf16_f32 v236, v236, v237
    v_cvt_pk_bf16_f32 v238, v238, v239
    v_mfma_f32_16x16x32_bf16 v[204:207], a[72:75], a[56:59], v[204:207]
    v_accvgpr_write_b32 a62, v236
    v_accvgpr_write_b32 a63, v238
    v_fma_f32 v191, v191, s34, v32
    v_exp_f32 v172, v172
    v_mfma_f32_16x16x32_bf16 v[204:207], a[76:79], a[60:63], v[204:207]
    buffer_load_dwordx4 v8, s[8:11], s40 offen offset:3072 nt lds
    v_exp_f32 v173, v173
    v_mfma_f32_16x16x32_bf16 v[220:223], a[80:83], a[48:51], v[32:35]
    s_add_u32 m0, s39, 114688
    v_exp_f32 v174, v174
    v_mfma_f32_16x16x32_bf16 v[220:223], a[84:87], a[52:55], v[220:223]
    v_exp_f32 v175, v175
    v_mfma_f32_16x16x32_bf16 v[220:223], a[88:91], a[56:59], v[220:223]
    v_exp_f32 v188, v188
    v_mfma_f32_16x16x32_bf16 v[220:223], a[92:95], a[60:63], v[220:223]
    buffer_load_dwordx4 v5, s[12:15], s41 offen offset:0 nt lds
    v_exp_f32 v189, v189
    v_mfma_f32_16x16x32_bf16 v[56:59], a[96:99], a[48:51], v[32:35]
    v_exp_f32 v190, v190
    v_mfma_f32_16x16x32_bf16 v[56:59], a[100:103], a[52:55], v[56:59]
    v_exp_f32 v191, v191
    v_mfma_f32_16x16x32_bf16 v[56:59], a[104:107], a[56:59], v[56:59]
    v_cvt_pk_bf16_f32 v92, v172, v173
    v_cvt_pk_bf16_f32 v93, v174, v175
    v_mfma_f32_16x16x32_bf16 v[56:59], a[108:111], a[60:63], v[56:59]
    buffer_load_dwordx4 v5, s[12:15], s41 offen offset:1024 nt lds
    v_cvt_pk_bf16_f32 v94, v188, v189
    v_mfma_f32_16x16x32_bf16 v[140:143], a[212:215], v[76:79], 0
    ds_read_b64_tr_b16 a[176:177], v2 offset:768
    v_cvt_pk_bf16_f32 v95, v190, v191
    v_exp_f32 v204, v204
    v_exp_f32 v205, v205
    v_mfma_f32_16x16x32_bf16 v[140:143], a[216:219], v[92:95], v[140:143]
    buffer_load_dwordx4 v5, s[12:15], s41 offen offset:2048 nt lds
    v_mfma_f32_16x16x32_bf16 v[156:159], a[220:223], v[76:79], 0
    v_exp_f32 v206, v206
    v_mfma_f32_16x16x32_bf16 v[156:159], a[224:227], v[92:95], v[156:159]
    buffer_load_dwordx4 v5, s[12:15], s41 offen offset:3072 nt lds
    v_mfma_f32_16x16x32_bf16 v[172:175], a[228:231], v[76:79], 0
    s_add_u32 m0, s66, 0
    v_exp_f32 v207, v207
    v_mfma_f32_16x16x32_bf16 v[172:175], a[232:235], v[92:95], v[172:175]
    buffer_load_dwordx4 v5, s[4:7], s30 offen offset:0 nt lds
    v_mfma_f32_16x16x32_bf16 v[188:191], a[236:239], v[76:79], 0
    v_cvt_pk_bf16_f32 v108, v204, v205
    v_cvt_pk_bf16_f32 v109, v206, v207
    v_mfma_f32_16x16x32_bf16 v[188:191], a[240:243], v[92:95], v[188:191]
    v_exp_f32 v220, v220
    v_exp_f32 v221, v221
    v_exp_f32 v222, v222
    v_mfma_f32_16x16x32_bf16 v[60:63], a[112:115], a[48:51], v[32:35]
    v_exp_f32 v223, v223
    v_mfma_f32_16x16x32_bf16 v[60:63], a[116:119], a[52:55], v[60:63]
    v_cvt_pk_bf16_f32 v110, v220, v221
    v_cvt_pk_bf16_f32 v111, v222, v223
    v_mfma_f32_16x16x32_bf16 v[60:63], a[120:123], a[56:59], v[60:63]
    v_exp_f32 v56, v56
    v_mfma_f32_16x16x32_bf16 v[60:63], a[124:127], a[60:63], v[60:63]
    buffer_load_dwordx4 v6, s[4:7], s30 offen offset:1024 nt lds
    v_mfma_f32_16x16x32_bf16 v[204:207], v[240:243], v[76:79], 0
    v_exp_f32 v57, v57
    v_mfma_f32_16x16x32_bf16 v[204:207], v[244:247], v[92:95], v[204:207]
    buffer_load_dwordx4 v7, s[4:7], s30 offen offset:2048 nt lds
    v_mfma_f32_16x16x32_bf16 v[220:223], v[248:251], v[76:79], 0
    ds_read_b64_tr_b16 a[178:179], v2 offset:4864
    v_mfma_f32_16x16x32_bf16 v[220:223], v[252:255], v[92:95], v[220:223]
    ds_read_b64_tr_b16 a[180:181], v2 offset:8960
    ds_read_b64_tr_b16 a[182:183], v2 offset:13056
    ds_read_b64_tr_b16 a[184:185], v2 offset:776
    ds_read_b64_tr_b16 a[186:187], v2 offset:4872
    ds_read_b64_tr_b16 a[188:189], v2 offset:8968
    ds_read_b64_tr_b16 a[190:191], v2 offset:13064
    s_add_u32 m0, s39, 114688
    s_add_u32 s40, s28, 65536
    s_add_u32 s41, s28, 49152
    s_waitcnt lgkmcnt(0)
    s_waitcnt vmcnt(19)
    s_barrier
    s_branch L_cut
L_next:
    s_waitcnt lgkmcnt(0)
    v_mfma_f32_16x16x32_bf16 v[48:51], a[128:131], a[32:35], v[28:31]
    s_add_u32 s40, s28, 65536
    ds_read_b64_tr_b16 a[160:161], v2 offset:0
    ds_read_b64_tr_b16 a[162:163], v2 offset:4096
    v_mfma_f32_16x16x32_bf16 v[48:51], a[132:135], a[36:39], v[48:51]
    s_add_u32 s41, s28, 49152
    ds_read_b64_tr_b16 a[164:165], v2 offset:8192
    ds_read_b64_tr_b16 a[166:167], v2 offset:12288
    v_mfma_f32_16x16x32_bf16 v[48:51], a[136:139], a[40:43], v[48:51]
    s_add_u32 m0, s39, 0
    ds_read_b64_tr_b16 a[168:169], v2 offset:8
    v_mfma_f32_16x16x32_bf16 v[48:51], a[140:143], a[44:47], v[48:51]
    buffer_load_dwordx4 v5, s[8:11], s40 offen offset:0 nt lds
    v_mfma_f32_16x16x32_bf16 v[56:59], a[140:143], a[60:63], v[32:35]
    ds_read_b64_tr_b16 a[170:171], v2 offset:4104
    v_mfma_f32_16x16x32_bf16 v[56:59], a[136:139], a[56:59], v[56:59]
    ds_read_b64_tr_b16 a[172:173], v2 offset:8200
    v_mfma_f32_16x16x32_bf16 v[56:59], a[132:135], a[52:55], v[56:59]
    v_exp_f32 v40, v40
    v_mfma_f32_16x16x32_bf16 v[56:59], a[128:131], a[48:51], v[56:59]
    v_exp_f32 v41, v41
    v_exp_f32 v42, v42
    v_exp_f32 v43, v43
    v_cvt_pk_bf16_f32 v82, v40, v41
    v_cvt_pk_bf16_f32 v83, v42, v43
    v_mfma_f32_16x16x32_bf16 v[40:43], a[128:131], a[0:3], v[20:23]
    ds_read_b64_tr_b16 a[174:175], v2 offset:12296
    v_mfma_f32_16x16x32_bf16 v[40:43], a[132:135], a[4:7], v[40:43]
    v_exp_f32 v44, v44
    v_mfma_f32_16x16x32_bf16 v[40:43], a[136:139], a[8:11], v[40:43]
    v_exp_f32 v45, v45
    v_mfma_f32_16x16x32_bf16 v[40:43], a[140:143], a[12:15], v[40:43]
    v_exp_f32 v46, v46
    v_exp_f32 v47, v47
    v_cvt_pk_bf16_f32 v86, v44, v45
    v_cvt_pk_bf16_f32 v87, v46, v47
    v_mfma_f32_16x16x32_bf16 v[44:47], a[140:143], a[28:31], v[24:27]
    ds_read_b128 a[144:147], v1 offset:20480
    v_mfma_f32_16x16x32_bf16 v[44:47], a[136:139], a[24:27], v[44:47]
    ds_read_b64_tr_b16 a[176:177], v2 offset:256
    v_mfma_f32_16x16x32_bf16 v[44:47], a[132:135], a[20:23], v[44:47]
    v_exp_f32 v52, v52
    v_mfma_f32_16x16x32_bf16 v[44:47], a[128:131], a[16:19], v[44:47]
    s_waitcnt lgkmcnt(2)
    buffer_load_dwordx4 v6, s[8:11], s40 offen offset:1024 nt lds
    v_mfma_f32_16x16x32_bf16 v[128:131], a[160:163], v[64:67], 0
    ds_read_b128 a[148:151], v1 offset:20736
    v_mfma_f32_16x16x32_bf16 v[128:131], a[164:167], v[80:83], v[128:131]
    s_add_u32 m0, s66, 0
    ds_read_b64_tr_b16 a[178:179], v2 offset:4352
    v_mfma_f32_16x16x32_bf16 v[132:135], a[164:167], v[84:87], 0
    v_exp_f32 v53, v53
    v_mfma_f32_16x16x32_bf16 v[132:135], a[160:163], v[68:71], v[132:135]
    v_exp_f32 v54, v54
    v_mfma_f32_16x16x32_bf16 v[136:139], a[160:163], v[72:75], 0
    v_exp_f32 v55, v55
    v_cvt_pk_bf16_f32 v90, v52, v53
    v_cvt_pk_bf16_f32 v91, v54, v55
    v_exp_f32 v60, v60
    v_exp_f32 v61, v61
    v_mfma_f32_16x16x32_bf16 v[136:139], a[164:167], v[88:91], v[136:139]
    v_exp_f32 v62, v62
    v_exp_f32 v63, v63
    v_cvt_pk_bf16_f32 v94, v60, v61
    v_cvt_pk_bf16_f32 v95, v62, v63
    v_exp_f32 v40, v40
    v_exp_f32 v41, v41
    v_mfma_f32_16x16x32_bf16 v[140:143], a[164:167], v[92:95], 0
    ds_read_b128 a[152:155], v1 offset:20992
    v_cvt_pk_bf16_f32 v96, v40, v41
    v_mfma_f32_16x16x32_bf16 v[140:143], a[160:163], v[76:79], v[140:143]
    buffer_load_dwordx4 v5, s[4:7], s30 offen offset:0 nt lds
    v_mfma_f32_16x16x32_bf16 v[144:147], a[168:171], v[64:67], 0
    ds_read_b64_tr_b16 a[180:181], v2 offset:8448
    v_mfma_f32_16x16x32_bf16 v[144:147], a[172:175], v[80:83], v[144:147]
    ds_read_b128 a[156:159], v1 offset:21248
    v_mfma_f32_16x16x32_bf16 v[148:151], a[172:175], v[84:87], 0
    ds_read_b64_tr_b16 a[182:183], v2 offset:12544
    v_mfma_f32_16x16x32_bf16 v[148:151], a[168:171], v[68:71], v[148:151]
    s_add_u32 m0, s39, 0
    v_exp_f32 v42, v42
    v_mfma_f32_16x16x32_bf16 v[152:155], a[168:171], v[72:75], 0
    ds_read_b64_tr_b16 a[184:185], v2 offset:264
    v_mfma_f32_16x16x32_bf16 v[152:155], a[172:175], v[88:91], v[152:155]
    v_exp_f32 v43, v43
    v_mfma_f32_16x16x32_bf16 v[156:159], a[172:175], v[92:95], 0
    v_exp_f32 v44, v44
    v_mfma_f32_16x16x32_bf16 v[156:159], a[168:171], v[76:79], v[156:159]
    v_exp_f32 v45, v45
    v_mfma_f32_16x16x32_bf16 a[192:195], a[208:211], v[64:67], 0
    ds_read_b64_tr_b16 a[186:187], v2 offset:4360
    v_cvt_pk_bf16_f32 v97, v42, v43
    v_mfma_f32_16x16x32_bf16 a[192:195], a[208:211], v[80:83], a[192:195]
    s_waitcnt lgkmcnt(3)
    buffer_load_dwordx4 v7, s[8:11], s40 offen offset:2048 nt lds
    v_mfma_f32_16x16x32_bf16 v[40:43], a[144:147], a[0:3], v[20:23]
    v_exp_f32 v46, v46
    v_mfma_f32_16x16x32_bf16 v[40:43], a[148:151], a[4:7], v[40:43]
    v_exp_f32 v47, v47
    v_mfma_f32_16x16x32_bf16 v[40:43], a[152:155], a[8:11], v[40:43]
    v_cvt_pk_bf16_f32 v100, v44, v45
    v_cvt_pk_bf16_f32 v101, v46, v47
    v_mfma_f32_16x16x32_bf16 v[40:43], a[156:159], a[12:15], v[40:43]
    ds_read_b64_tr_b16 a[188:189], v2 offset:8456
    v_mfma_f32_16x16x32_bf16 v[44:47], a[156:159], a[28:31], v[24:27]
    v_exp_f32 v48, v48
    v_mfma_f32_16x16x32_bf16 v[44:47], a[152:155], a[24:27], v[44:47]
    v_exp_f32 v49, v49
    v_mfma_f32_16x16x32_bf16 v[44:47], a[148:151], a[20:23], v[44:47]
    ds_read_b64_tr_b16 a[190:191], v2 offset:12552
    v_cvt_pk_bf16_f32 v104, v48, v49
    v_mfma_f32_16x16x32_bf16 v[44:47], a[144:147], a[16:19], v[44:47]
    v_exp_f32 v40, v40
    v_mfma_f32_16x16x32_bf16 v[52:55], a[144:147], a[32:35], v[28:31]
    v_exp_f32 v41, v41
    v_mfma_f32_16x16x32_bf16 v[52:55], a[148:151], a[36:39], v[52:55]
    v_exp_f32 v42, v42
    v_mfma_f32_16x16x32_bf16 v[52:55], a[152:155], a[40:43], v[52:55]
    v_exp_f32 v43, v43
    v_mfma_f32_16x16x32_bf16 v[52:55], a[156:159], a[44:47], v[52:55]
    buffer_load_dwordx4 v8, s[8:11], s40 offen offset:3072 nt lds
    v_mfma_f32_16x16x32_bf16 v[60:63], a[156:159], a[60:63], v[32:35]
    ds_read_b128 a[128:131], v1 offset:24576
    v_cvt_pk_bf16_f32 v98, v40, v41
    v_mfma_f32_16x16x32_bf16 v[60:63], a[152:155], a[56:59], v[60:63]
    ds_read_b64_tr_b16 a[160:161], v2 offset:512
    v_cvt_pk_bf16_f32 v99, v42, v43
    v_mfma_f32_16x16x32_bf16 v[60:63], a[148:151], a[52:55], v[60:63]
    s_waitcnt lgkmcnt(2)
    v_exp_f32 v44, v44
    v_mfma_f32_16x16x32_bf16 v[60:63], a[144:147], a[48:51], v[60:63]
    s_add_u32 m0, s66, 0
    v_exp_f32 v45, v45
    v_mfma_f32_16x16x32_bf16 v[160:163], a[176:179], v[64:67], 0
    ds_read_b128 a[132:135], v1 offset:24832
    v_cvt_pk_bf16_f32 v102, v44, v45
    v_mfma_f32_16x16x32_bf16 v[160:163], a[180:183], v[80:83], v[160:163]
    ds_read_b64_tr_b16 a[162:163], v2 offset:4608
    v_mfma_f32_16x16x32_bf16 v[164:167], a[180:183], v[84:87], 0
    v_exp_f32 v46, v46
    v_mfma_f32_16x16x32_bf16 v[164:167], a[176:179], v[68:71], v[164:167]
    v_exp_f32 v47, v47
    v_mfma_f32_16x16x32_bf16 v[168:171], a[176:179], v[72:75], 0
    ds_read_b128 a[136:139], v1 offset:25088
    v_cvt_pk_bf16_f32 v103, v46, v47
    v_mfma_f32_16x16x32_bf16 v[168:171], a[180:183], v[88:91], v[168:171]
    buffer_load_dwordx4 v6, s[4:7], s30 offen offset:1024 nt lds
    v_mfma_f32_16x16x32_bf16 v[172:175], a[180:183], v[92:95], 0
    ds_read_b64_tr_b16 a[164:165], v2 offset:8704
    v_mfma_f32_16x16x32_bf16 v[172:175], a[176:179], v[76:79], v[172:175]
    v_exp_f32 v50, v50
    v_mfma_f32_16x16x32_bf16 v[176:179], a[184:187], v[64:67], 0
    s_add_u32 m0, s39, 114688
    ds_read_b128 a[140:143], v1 offset:25344
    v_mfma_f32_16x16x32_bf16 v[176:179], a[188:191], v[80:83], v[176:179]
    ds_read_b64_tr_b16 a[166:167], v2 offset:12800
    v_mfma_f32_16x16x32_bf16 v[180:183], a[188:191], v[84:87], 0
    v_exp_f32 v51, v51
    v_mfma_f32_16x16x32_bf16 v[180:183], a[184:187], v[68:71], v[180:183]
    buffer_store_dwordx4 a[212:215], v3, s[72:75], s76 offen offset:128 nt
    v_mfma_f32_16x16x32_bf16 v[184:187], a[184:187], v[72:75], 0
    ds_read_b64_tr_b16 a[168:169], v2 offset:520
    v_cvt_pk_bf16_f32 v105, v50, v51
    v_mfma_f32_16x16x32_bf16 v[184:187], a[188:191], v[88:91], v[184:187]
    v_exp_f32 v56, v56
    v_mfma_f32_16x16x32_bf16 v[188:191], a[188:191], v[92:95], 0
    v_exp_f32 v57, v57
    v_mfma_f32_16x16x32_bf16 v[188:191], a[184:187], v[76:79], v[188:191]
    s_waitcnt lgkmcnt(2)
    buffer_load_dwordx4 v5, s[12:15], s41 offen offset:0 nt lds
    v_mfma_f32_16x16x32_bf16 a[196:199], a[208:211], v[68:71], 0
    ds_read_b64_tr_b16 a[170:171], v2 offset:4616
    v_cvt_pk_bf16_f32 v108, v56, v57
    v_mfma_f32_16x16x32_bf16 a[196:199], a[208:211], v[84:87], a[196:199]
    v_exp_f32 v58, v58
    v_mfma_f32_16x16x32_bf16 v[40:43], a[128:131], a[0:3], v[20:23]
    v_exp_f32 v59, v59
    v_mfma_f32_16x16x32_bf16 v[40:43], a[132:135], a[4:7], v[40:43]
    v_exp_f32 v52, v52
    v_mfma_f32_16x16x32_bf16 v[40:43], a[136:139], a[8:11], v[40:43]
    ds_read_b64_tr_b16 a[172:173], v2 offset:8712
    v_cvt_pk_bf16_f32 v109, v58, v59
    v_mfma_f32_16x16x32_bf16 v[40:43], a[140:143], a[12:15], v[40:43]
    v_exp_f32 v53, v53
    v_mfma_f32_16x16x32_bf16 v[44:47], a[140:143], a[28:31], v[24:27]
    v_exp_f32 v54, v54
    v_mfma_f32_16x16x32_bf16 v[44:47], a[136:139], a[24:27], v[44:47]
    v_exp_f32 v55, v55
    v_mfma_f32_16x16x32_bf16 v[44:47], a[132:135], a[20:23], v[44:47]
    ds_read_b64_tr_b16 a[174:175], v2 offset:12808
    v_cvt_pk_bf16_f32 v106, v52, v53
    v_mfma_f32_16x16x32_bf16 v[44:47], a[128:131], a[16:19], v[44:47]
    buffer_load_dwordx4 v5, s[12:15], s41 offen offset:1024 nt lds
    v_mfma_f32_16x16x32_bf16 v[48:51], a[128:131], a[32:35], v[28:31]
    v_exp_f32 v40, v40
    v_mfma_f32_16x16x32_bf16 v[48:51], a[132:135], a[36:39], v[48:51]
    v_exp_f32 v41, v41
    v_mfma_f32_16x16x32_bf16 v[48:51], a[136:139], a[40:43], v[48:51]
    v_exp_f32 v42, v42
    v_mfma_f32_16x16x32_bf16 v[48:51], a[140:143], a[44:47], v[48:51]
    v_exp_f32 v43, v43
    v_mfma_f32_16x16x32_bf16 v[56:59], a[140:143], a[60:63], v[32:35]
    ds_read_b128 a[144:147], v1 offset:28672
    v_cvt_pk_bf16_f32 v112, v40, v41
    v_mfma_f32_16x16x32_bf16 v[56:59], a[136:139], a[56:59], v[56:59]
    ds_read_b64_tr_b16 a[176:177], v2 offset:768
    v_cvt_pk_bf16_f32 v113, v42, v43
    v_mfma_f32_16x16x32_bf16 v[56:59], a[132:135], a[52:55], v[56:59]
    s_waitcnt lgkmcnt(2)
    v_exp_f32 v44, v44
    v_mfma_f32_16x16x32_bf16 v[56:59], a[128:131], a[48:51], v[56:59]
    v_exp_f32 v45, v45
    v_mfma_f32_16x16x32_bf16 v[192:195], a[160:163], v[64:67], 0
    ds_read_b128 a[148:151], v1 offset:28928
    v_cvt_pk_bf16_f32 v116, v44, v45
    v_mfma_f32_16x16x32_bf16 v[192:195], a[164:167], v[80:83], v[192:195]
    buffer_load_dwordx4 v5, s[12:15], s41 offen offset:2048 nt lds
    v_mfma_f32_16x16x32_bf16 v[196:199], a[164:167], v[84:87], 0
    ds_read_b64_tr_b16 a[178:179], v2 offset:4864
    v_cvt_pk_bf16_f32 v107, v54, v55
    v_mfma_f32_16x16x32_bf16 v[196:199], a[160:163], v[68:71], v[196:199]
    v_exp_f32 v46, v46
    v_mfma_f32_16x16x32_bf16 v[200:203], a[160:163], v[72:75], 0
    s_add_u32 m0, s66, 0
    ds_read_b128 a[152:155], v1 offset:29184
    v_mfma_f32_16x16x32_bf16 v[200:203], a[164:167], v[88:91], v[200:203]
    ds_read_b64_tr_b16 a[180:181], v2 offset:8960
    v_mfma_f32_16x16x32_bf16 v[204:207], a[164:167], v[92:95], 0
    v_exp_f32 v47, v47
    v_mfma_f32_16x16x32_bf16 v[204:207], a[160:163], v[76:79], v[204:207]
    v_exp_f32 v60, v60
    v_mfma_f32_16x16x32_bf16 v[208:211], a[168:171], v[64:67], 0
    ds_read_b128 a[156:159], v1 offset:29440
    v_cvt_pk_bf16_f32 v117, v46, v47
    v_mfma_f32_16x16x32_bf16 v[208:211], a[172:175], v[80:83], v[208:211]
    ds_read_b64_tr_b16 a[182:183], v2 offset:13056
    v_mfma_f32_16x16x32_bf16 v[212:215], a[172:175], v[84:87], 0
    v_exp_f32 v61, v61
    v_mfma_f32_16x16x32_bf16 v[212:215], a[168:171], v[68:71], v[212:215]
    buffer_load_dwordx4 v7, s[4:7], s30 offen offset:2048 nt lds
    v_mfma_f32_16x16x32_bf16 v[216:219], a[168:171], v[72:75], 0
    ds_read_b64_tr_b16 a[184:185], v2 offset:776
    v_cvt_pk_bf16_f32 v110, v60, v61
    v_mfma_f32_16x16x32_bf16 v[216:219], a[172:175], v[88:91], v[216:219]
    v_exp_f32 v62, v62
    v_mfma_f32_16x16x32_bf16 v[220:223], a[172:175], v[92:95], 0
    s_add_u32 m0, s39, 114688
    v_exp_f32 v63, v63
    v_mfma_f32_16x16x32_bf16 v[220:223], a[168:171], v[76:79], v[220:223]
    v_exp_f32 v48, v48
    v_mfma_f32_16x16x32_bf16 a[200:203], a[208:211], v[72:75], 0
    s_waitcnt lgkmcnt(2)
    ds_read_b64_tr_b16 a[186:187], v2 offset:4872
    v_cvt_pk_bf16_f32 v111, v62, v63
    v_mfma_f32_16x16x32_bf16 a[200:203], a[208:211], v[88:91], a[200:203]
    v_exp_f32 v49, v49
    v_mfma_f32_16x16x32_bf16 v[40:43], a[144:147], a[0:3], v[20:23]
    v_exp_f32 v50, v50
    v_mfma_f32_16x16x32_bf16 v[40:43], a[148:151], a[4:7], v[40:43]
    v_exp_f32 v51, v51
    v_mfma_f32_16x16x32_bf16 v[40:43], a[152:155], a[8:11], v[40:43]
    ds_read_b64_tr_b16 a[188:189], v2 offset:8968
    v_cvt_pk_bf16_f32 v120, v48, v49
    v_mfma_f32_16x16x32_bf16 v[40:43], a[156:159], a[12:15], v[40:43]
    buffer_load_dwordx4 v5, s[12:15], s41 offen offset:3072 nt lds
    v_mfma_f32_16x16x32_bf16 v[44:47], a[156:159], a[28:31], v[24:27]
    v_exp_f32 v56, v56
    v_mfma_f32_16x16x32_bf16 v[44:47], a[152:155], a[24:27], v[44:47]
    v_exp_f32 v57, v57
    v_mfma_f32_16x16x32_bf16 v[44:47], a[148:151], a[20:23], v[44:47]
    ds_read_b64_tr_b16 a[190:191], v2 offset:13064
    v_cvt_pk_bf16_f32 v121, v50, v51
    v_mfma_f32_16x16x32_bf16 v[44:47], a[144:147], a[16:19], v[44:47]
    v_exp_f32 v40, v40
    v_mfma_f32_16x16x32_bf16 v[52:55], a[144:147], a[32:35], v[28:31]
    v_exp_f32 v41, v41
    v_mfma_f32_16x16x32_bf16 v[52:55], a[148:151], a[36:39], v[52:55]
    v_exp_f32 v42, v42
    v_mfma_f32_16x16x32_bf16 v[52:55], a[152:155], a[40:43], v[52:55]
    v_exp_f32 v43, v43
    v_mfma_f32_16x16x32_bf16 v[52:55], a[156:159], a[44:47], v[52:55]
    v_cvt_pk_bf16_f32 v114, v40, v41
    v_cvt_pk_bf16_f32 v115, v42, v43
    v_mfma_f32_16x16x32_bf16 v[60:63], a[156:159], a[60:63], v[32:35]
    v_exp_f32 v44, v44
    v_mfma_f32_16x16x32_bf16 v[60:63], a[152:155], a[56:59], v[60:63]
    s_waitcnt lgkmcnt(0)
    v_exp_f32 v45, v45
    v_mfma_f32_16x16x32_bf16 v[60:63], a[148:151], a[52:55], v[60:63]
    s_waitcnt vmcnt(26)
    v_exp_f32 v46, v46
    v_mfma_f32_16x16x32_bf16 v[60:63], a[144:147], a[48:51], v[60:63]
    s_barrier
L_cut:
    v_mfma_f32_16x16x32_bf16 v[224:227], a[176:179], v[64:67], 0
    s_add_u32 s40, s28, 81920
    ds_read_b128 a[128:131], v1 offset:32768
    v_cvt_pk_bf16_f32 v118, v44, v45
    v_mfma_f32_16x16x32_bf16 v[224:227], a[180:183], v[80:83], v[224:227]
    s_add_u32 s41, s28, 65536
    ds_read_b64_tr_b16 a[160:161], v2 offset:16384
    v_cvt_pk_bf16_f32 v124, v56, v57
    v_mfma_f32_16x16x32_bf16 v[228:231], a[180:183], v[84:87], 0
    s_add_u32 m0, s39, 16384
    ds_read_b128 a[132:135], v1 offset:33024
    v_mfma_f32_16x16x32_bf16 v[228:231], a[176:179], v[68:71], v[228:231]
    ds_read_b64_tr_b16 a[162:163], v2 offset:20480
    v_mfma_f32_16x16x32_bf16 v[232:235], a[176:179], v[72:75], 0
    ds_read_b128 a[136:139], v1 offset:33280
    v_mfma_f32_16x16x32_bf16 v[232:235], a[180:183], v[88:91], v[232:235]
    buffer_load_dwordx4 v5, s[8:11], s40 offen offset:0 nt lds
    v_mfma_f32_16x16x32_bf16 v[236:239], a[180:183], v[92:95], 0
    ds_read_b64_tr_b16 a[164:165], v2 offset:24576
    v_mfma_f32_16x16x32_bf16 v[236:239], a[176:179], v[76:79], v[236:239]
    v_exp_f32 v47, v47
    v_mfma_f32_16x16x32_bf16 v[240:243], a[184:187], v[64:67], 0
    ds_read_b128 a[140:143], v1 offset:33536
    v_cvt_pk_bf16_f32 v119, v46, v47
    v_mfma_f32_16x16x32_bf16 v[240:243], a[188:191], v[80:83], v[240:243]
    ds_read_b64_tr_b16 a[166:167], v2 offset:28672
    v_mfma_f32_16x16x32_bf16 v[244:247], a[188:191], v[84:87], 0
    v_exp_f32 v58, v58
    v_mfma_f32_16x16x32_bf16 v[244:247], a[184:187], v[68:71], v[244:247]
    v_exp_f32 v59, v59
    v_mfma_f32_16x16x32_bf16 v[248:251], a[184:187], v[72:75], 0
    ds_read_b64_tr_b16 a[168:169], v2 offset:16392
    v_cvt_pk_bf16_f32 v125, v58, v59
    v_mfma_f32_16x16x32_bf16 v[248:251], a[188:191], v[88:91], v[248:251]
    v_exp_f32 v52, v52
    v_mfma_f32_16x16x32_bf16 v[252:255], a[188:191], v[92:95], 0
    v_exp_f32 v53, v53
    v_mfma_f32_16x16x32_bf16 v[252:255], a[184:187], v[76:79], v[252:255]
    v_exp_f32 v54, v54
    v_mfma_f32_16x16x32_bf16 a[204:207], a[208:211], v[76:79], 0
    s_waitcnt lgkmcnt(2)
    ds_read_b64_tr_b16 a[170:171], v2 offset:20488
    v_cvt_pk_bf16_f32 v122, v52, v53
    v_mfma_f32_16x16x32_bf16 a[204:207], a[208:211], v[92:95], a[204:207]
    buffer_load_dwordx4 v6, s[8:11], s40 offen offset:1024 nt lds
    v_mfma_f32_16x16x32_bf16 v[40:43], a[128:131], a[0:3], v[20:23]
    v_exp_f32 v55, v55
    v_mfma_f32_16x16x32_bf16 v[40:43], a[132:135], a[4:7], v[40:43]
    v_exp_f32 v60, v60
    v_mfma_f32_16x16x32_bf16 v[40:43], a[136:139], a[8:11], v[40:43]
    ds_read_b64_tr_b16 a[172:173], v2 offset:24584
    v_cvt_pk_bf16_f32 v123, v54, v55
    v_mfma_f32_16x16x32_bf16 v[40:43], a[140:143], a[12:15], v[40:43]
    v_exp_f32 v61, v61
    v_mfma_f32_16x16x32_bf16 v[44:47], a[140:143], a[28:31], v[24:27]
    v_exp_f32 v62, v62
    v_mfma_f32_16x16x32_bf16 v[44:47], a[136:139], a[24:27], v[44:47]
    s_add_u32 m0, s66, 0
    v_exp_f32 v63, v63
    v_mfma_f32_16x16x32_bf16 v[44:47], a[132:135], a[20:23], v[44:47]
    ds_read_b64_tr_b16 a[174:175], v2 offset:28680
    v_cvt_pk_bf16_f32 v126, v60, v61
    v_mfma_f32_16x16x32_bf16 v[44:47], a[128:131], a[16:19], v[44:47]
    v_exp_f32 v40, v40
    v_mfma_f32_16x16x32_bf16 v[48:51], a[128:131], a[32:35], v[28:31]
    v_exp_f32 v41, v41
    v_mfma_f32_16x16x32_bf16 v[48:51], a[132:135], a[36:39], v[48:51]
    v_cvt_pk_bf16_f32 v127, v62, v63
    v_cvt_pk_bf16_f32 v64, v40, v41
    v_mfma_f32_16x16x32_bf16 v[48:51], a[136:139], a[40:43], v[48:51]
    v_exp_f32 v42, v42
    v_mfma_f32_16x16x32_bf16 v[48:51], a[140:143], a[44:47], v[48:51]
    buffer_load_dwordx4 v8, s[4:7], s30 offen offset:3072 nt lds
    v_mfma_f32_16x16x32_bf16 v[56:59], a[140:143], a[60:63], v[32:35]
    ds_read_b128 a[144:147], v1 offset:36864
    v_mfma_f32_16x16x32_bf16 v[56:59], a[136:139], a[56:59], v[56:59]
    ds_read_b64_tr_b16 a[176:177], v2 offset:16640
    v_mfma_f32_16x16x32_bf16 v[56:59], a[132:135], a[52:55], v[56:59]
    s_waitcnt lgkmcnt(2)
    v_exp_f32 v43, v43
    v_mfma_f32_16x16x32_bf16 v[56:59], a[128:131], a[48:51], v[56:59]
    v_exp_f32 v44, v44
    v_mfma_f32_16x16x32_bf16 v[128:131], a[160:163], v[96:99], v[128:131]
    s_add_u32 m0, s39, 16384
    ds_read_b128 a[148:151], v1 offset:37120
    v_cvt_pk_bf16_f32 v65, v42, v43
    v_mfma_f32_16x16x32_bf16 v[128:131], a[164:167], v[112:115], v[128:131]
    ds_read_b64_tr_b16 a[178:179], v2 offset:20736
    v_mfma_f32_16x16x32_bf16 v[132:135], a[164:167], v[116:119], v[132:135]
    v_exp_f32 v45, v45
    v_mfma_f32_16x16x32_bf16 v[132:135], a[160:163], v[100:103], v[132:135]
    v_exp_f32 v46, v46
    v_mfma_f32_16x16x32_bf16 v[136:139], a[160:163], v[104:107], v[136:139]
    ds_read_b128 a[152:155], v1 offset:37376
    v_cvt_pk_bf16_f32 v68, v44, v45
    v_mfma_f32_16x16x32_bf16 v[136:139], a[164:167], v[120:123], v[136:139]
    ds_read_b64_tr_b16 a[180:181], v2 offset:24832
    v_mfma_f32_16x16x32_bf16 v[140:143], a[164:167], v[124:127], v[140:143]
    v_exp_f32 v47, v47
    v_mfma_f32_16x16x32_bf16 v[140:143], a[160:163], v[108:111], v[140:143]
    buffer_load_dwordx4 v7, s[8:11], s40 offen offset:2048 nt lds
    v_mfma_f32_16x16x32_bf16 v[144:147], a[168:171], v[96:99], v[144:147]
    ds_read_b128 a[156:159], v1 offset:37632
    v_cvt_pk_bf16_f32 v69, v46, v47
    v_mfma_f32_16x16x32_bf16 v[144:147], a[172:175], v[112:115], v[144:147]
    ds_read_b64_tr_b16 a[182:183], v2 offset:28928
    v_mfma_f32_16x16x32_bf16 v[148:151], a[172:175], v[116:119], v[148:151]
    v_exp_f32 v48, v48
    v_mfma_f32_16x16x32_bf16 v[148:151], a[168:171], v[100:103], v[148:151]
    v_exp_f32 v49, v49
    v_mfma_f32_16x16x32_bf16 v[152:155], a[168:171], v[104:107], v[152:155]
    ds_read_b64_tr_b16 a[184:185], v2 offset:16648
    v_cvt_pk_bf16_f32 v72, v48, v49
    v_mfma_f32_16x16x32_bf16 v[152:155], a[172:175], v[120:123], v[152:155]
    v_exp_f32 v50, v50
    v_mfma_f32_16x16x32_bf16 v[156:159], a[172:175], v[124:127], v[156:159]
    v_exp_f32 v51, v51
    v_mfma_f32_16x16x32_bf16 v[156:159], a[168:171], v[108:111], v[156:159]
    v_exp_f32 v56, v56
    v_mfma_f32_16x16x32_bf16 a[192:195], a[208:211], v[96:99], a[192:195]
    s_waitcnt lgkmcnt(2)
    ds_read_b64_tr_b16 a[186:187], v2 offset:20744
    v_cvt_pk_bf16_f32 v73, v50, v51
    v_mfma_f32_16x16x32_bf16 a[192:195], a[208:211], v[112:115], a[192:195]
    v_exp_f32 v57, v57
    v_mfma_f32_16x16x32_bf16 v[40:43], a[144:147], a[0:3], v[20:23]
    v_exp_f32 v58, v58
    v_mfma_f32_16x16x32_bf16 v[40:43], a[148:151], a[4:7], v[40:43]
    v_exp_f32 v59, v59
    v_mfma_f32_16x16x32_bf16 v[40:43], a[152:155], a[8:11], v[40:43]
    ds_read_b64_tr_b16 a[188:189], v2 offset:24840
    v_cvt_pk_bf16_f32 v76, v56, v57
    v_mfma_f32_16x16x32_bf16 v[40:43], a[156:159], a[12:15], v[40:43]
    buffer_load_dwordx4 v8, s[8:11], s40 offen offset:3072 nt lds
    v_mfma_f32_16x16x32_bf16 v[44:47], a[156:159], a[28:31], v[24:27]
    v_cvt_pk_bf16_f32 v77, v58, v59
    v_mfma_f32_16x16x32_bf16 v[44:47], a[152:155], a[24:27], v[44:47]
    v_mfma_f32_16x16x32_bf16 v[44:47], a[148:151], a[20:23], v[44:47]
    s_add_u32 m0, s66, 4096
    ds_read_b64_tr_b16 a[190:191], v2 offset:28936
    v_mfma_f32_16x16x32_bf16 v[44:47], a[144:147], a[16:19], v[44:47]
    v_exp_f32 v40, v40
    v_mfma_f32_16x16x32_bf16 v[52:55], a[144:147], a[32:35], v[28:31]
    v_exp_f32 v41, v41
    v_mfma_f32_16x16x32_bf16 v[52:55], a[148:151], a[36:39], v[52:55]
    v_exp_f32 v42, v42
    v_mfma_f32_16x16x32_bf16 v[52:55], a[152:155], a[40:43], v[52:55]
    v_exp_f32 v43, v43
    v_mfma_f32_16x16x32_bf16 v[52:55], a[156:159], a[44:47], v[52:55]
    v_cvt_pk_bf16_f32 v66, v40, v41
    v_cvt_pk_bf16_f32 v67, v42, v43
    v_mfma_f32_16x16x32_bf16 v[60:63], a[156:159], a[60:63], v[32:35]
    ds_read_b128 a[128:131], v1 offset:40960
    v_mfma_f32_16x16x32_bf16 v[60:63], a[152:155], a[56:59], v[60:63]
    ds_read_b64_tr_b16 a[160:161], v2 offset:16896
    v_mfma_f32_16x16x32_bf16 v[60:63], a[148:151], a[52:55], v[60:63]
    s_waitcnt lgkmcnt(2)
    v_exp_f32 v44, v44
    v_mfma_f32_16x16x32_bf16 v[60:63], a[144:147], a[48:51], v[60:63]
    buffer_load_dwordx4 v5, s[4:7], s31 offen offset:0 nt lds
    v_mfma_f32_16x16x32_bf16 v[160:163], a[176:179], v[96:99], v[160:163]
    ds_read_b128 a[132:135], v1 offset:41216
    v_mfma_f32_16x16x32_bf16 v[160:163], a[180:183], v[112:115], v[160:163]
    s_add_u32 m0, s39, 65536
    ds_read_b64_tr_b16 a[162:163], v2 offset:20992
    v_mfma_f32_16x16x32_bf16 v[164:167], a[180:183], v[116:119], v[164:167]
    v_exp_f32 v45, v45
    v_mfma_f32_16x16x32_bf16 v[164:167], a[176:179], v[100:103], v[164:167]
    buffer_store_dwordx4 a[216:219], v3, s[72:75], s76 offen offset:2176 nt
    v_mfma_f32_16x16x32_bf16 v[168:171], a[176:179], v[104:107], v[168:171]
    ds_read_b128 a[136:139], v1 offset:41472
    v_cvt_pk_bf16_f32 v70, v44, v45
    v_mfma_f32_16x16x32_bf16 v[168:171], a[180:183], v[120:123], v[168:171]
    ds_read_b64_tr_b16 a[164:165], v2 offset:25088
    v_mfma_f32_16x16x32_bf16 v[172:175], a[180:183], v[124:127], v[172:175]
    v_exp_f32 v46, v46
    v_mfma_f32_16x16x32_bf16 v[172:175], a[176:179], v[108:111], v[172:175]
    buffer_load_dwordx4 v5, s[12:15], s41 offen offset:0 nt lds
    v_mfma_f32_16x16x32_bf16 v[176:179], a[184:187], v[96:99], v[176:179]
    ds_read_b128 a[140:143], v1 offset:41728
    v_mfma_f32_16x16x32_bf16 v[176:179], a[188:191], v[112:115], v[176:179]
    ds_read_b64_tr_b16 a[166:167], v2 offset:29184
    v_mfma_f32_16x16x32_bf16 v[180:183], a[188:191], v[116:119], v[180:183]
    v_exp_f32 v47, v47
    v_mfma_f32_16x16x32_bf16 v[180:183], a[184:187], v[100:103], v[180:183]
    v_exp_f32 v52, v52
    v_mfma_f32_16x16x32_bf16 v[184:187], a[184:187], v[104:107], v[184:187]
    ds_read_b64_tr_b16 a[168:169], v2 offset:16904
    v_cvt_pk_bf16_f32 v71, v46, v47
    v_mfma_f32_16x16x32_bf16 v[184:187], a[188:191], v[120:123], v[184:187]
    v_exp_f32 v53, v53
    v_mfma_f32_16x16x32_bf16 v[188:191], a[188:191], v[124:127], v[188:191]
    v_exp_f32 v54, v54
    v_mfma_f32_16x16x32_bf16 v[188:191], a[184:187], v[108:111], v[188:191]
    v_exp_f32 v55, v55
    v_mfma_f32_16x16x32_bf16 a[196:199], a[208:211], v[100:103], a[196:199]
    s_waitcnt lgkmcnt(2)
    ds_read_b64_tr_b16 a[170:171], v2 offset:21000
    v_cvt_pk_bf16_f32 v74, v52, v53
    v_mfma_f32_16x16x32_bf16 a[196:199], a[208:211], v[116:119], a[196:199]
    v_exp_f32 v60, v60
    v_mfma_f32_16x16x32_bf16 v[40:43], a[128:131], a[0:3], v[20:23]
    v_exp_f32 v61, v61
    v_mfma_f32_16x16x32_bf16 v[40:43], a[132:135], a[4:7], v[40:43]
    v_cvt_pk_bf16_f32 v75, v54, v55
    v_cvt_pk_bf16_f32 v78, v60, v61
    v_mfma_f32_16x16x32_bf16 v[40:43], a[136:139], a[8:11], v[40:43]
    ds_read_b64_tr_b16 a[172:173], v2 offset:25096
    v_mfma_f32_16x16x32_bf16 v[40:43], a[140:143], a[12:15], v[40:43]
    buffer_load_dwordx4 v5, s[12:15], s41 offen offset:1024 nt lds
    v_mfma_f32_16x16x32_bf16 v[44:47], a[140:143], a[28:31], v[24:27]
    v_exp_f32 v62, v62
    v_mfma_f32_16x16x32_bf16 v[44:47], a[136:139], a[24:27], v[44:47]
    v_exp_f32 v63, v63
    v_mfma_f32_16x16x32_bf16 v[44:47], a[132:135], a[20:23], v[44:47]
    ds_read_b64_tr_b16 a[174:175], v2 offset:29192
    v_cvt_pk_bf16_f32 v79, v62, v63
    v_mfma_f32_16x16x32_bf16 v[44:47], a[128:131], a[16:19], v[44:47]
    v_exp_f32 v40, v40
    v_mfma_f32_16x16x32_bf16 v[48:51], a[128:131], a[32:35], v[28:31]
    v_exp_f32 v41, v41
    v_mfma_f32_16x16x32_bf16 v[48:51], a[132:135], a[36:39], v[48:51]
    v_exp_f32 v42, v42
    v_mfma_f32_16x16x32_bf16 v[48:51], a[136:139], a[40:43], v[48:51]
    v_exp_f32 v43, v43
    v_mfma_f32_16x16x32_bf16 v[48:51], a[140:143], a[44:47], v[48:51]
    v_cvt_pk_bf16_f32 v80, v40, v41
    v_cvt_pk_bf16_f32 v81, v42, v43
    v_mfma_f32_16x16x32_bf16 v[56:59], a[140:143], a[60:63], v[32:35]
    ds_read_b128 a[144:147], v1 offset:45056
    v_mfma_f32_16x16x32_bf16 v[56:59], a[136:139], a[56:59], v[56:59]
    ds_read_b64_tr_b16 a[176:177], v2 offset:17152
    v_mfma_f32_16x16x32_bf16 v[56:59], a[132:135], a[52:55], v[56:59]
    s_waitcnt lgkmcnt(2)
    v_exp_f32 v44, v44
    v_mfma_f32_16x16x32_bf16 v[56:59], a[128:131], a[48:51], v[56:59]
    buffer_load_dwordx4 v5, s[12:15], s41 offen offset:2048 nt lds
    v_mfma_f32_16x16x32_bf16 v[192:195], a[160:163], v[96:99], v[192:195]
    ds_read_b128 a[148:151], v1 offset:45312
    v_mfma_f32_16x16x32_bf16 v[192:195], a[164:167], v[112:115], v[192:195]
    ds_read_b64_tr_b16 a[178:179], v2 offset:21248
    v_mfma_f32_16x16x32_bf16 v[196:199], a[164:167], v[116:119], v[196:199]
    s_add_u32 m0, s66, 4096
    v_exp_f32 v45, v45
    v_mfma_f32_16x16x32_bf16 v[196:199], a[160:163], v[100:103], v[196:199]
    v_exp_f32 v46, v46
    v_mfma_f32_16x16x32_bf16 v[200:203], a[160:163], v[104:107], v[200:203]
    ds_read_b128 a[152:155], v1 offset:45568
    v_cvt_pk_bf16_f32 v84, v44, v45
    v_mfma_f32_16x16x32_bf16 v[200:203], a[164:167], v[120:123], v[200:203]
    ds_read_b64_tr_b16 a[180:181], v2 offset:25344
    v_mfma_f32_16x16x32_bf16 v[204:207], a[164:167], v[124:127], v[204:207]
    v_exp_f32 v47, v47
    v_mfma_f32_16x16x32_bf16 v[204:207], a[160:163], v[108:111], v[204:207]
    v_exp_f32 v48, v48
    v_mfma_f32_16x16x32_bf16 v[208:211], a[168:171], v[96:99], v[208:211]
    ds_read_b128 a[156:159], v1 offset:45824
    v_cvt_pk_bf16_f32 v85, v46, v47
    v_mfma_f32_16x16x32_bf16 v[208:211], a[172:175], v[112:115], v[208:211]
    buffer_load_dwordx4 v6, s[4:7], s31 offen offset:1024 nt lds
    v_mfma_f32_16x16x32_bf16 v[212:215], a[172:175], v[116:119], v[212:215]
    ds_read_b64_tr_b16 a[182:183], v2 offset:29440
    v_mfma_f32_16x16x32_bf16 v[212:215], a[168:171], v[100:103], v[212:215]
    v_exp_f32 v49, v49
    v_mfma_f32_16x16x32_bf16 v[216:219], a[168:171], v[104:107], v[216:219]
    ds_read_b64_tr_b16 a[184:185], v2 offset:17160
    v_cvt_pk_bf16_f32 v88, v48, v49
    v_mfma_f32_16x16x32_bf16 v[216:219], a[172:175], v[120:123], v[216:219]
    v_exp_f32 v50, v50
    v_mfma_f32_16x16x32_bf16 v[220:223], a[172:175], v[124:127], v[220:223]
    s_add_u32 m0, s39, 65536
    v_exp_f32 v51, v51
    v_mfma_f32_16x16x32_bf16 v[220:223], a[168:171], v[108:111], v[220:223]
    v_exp_f32 v56, v56
    v_mfma_f32_16x16x32_bf16 a[200:203], a[208:211], v[104:107], a[200:203]
    s_waitcnt lgkmcnt(2)
    ds_read_b64_tr_b16 a[186:187], v2 offset:21256
    v_cvt_pk_bf16_f32 v89, v50, v51
    v_mfma_f32_16x16x32_bf16 a[200:203], a[208:211], v[120:123], a[200:203]
    v_exp_f32 v57, v57
    v_mfma_f32_16x16x32_bf16 v[40:43], a[144:147], a[0:3], v[20:23]
    v_exp_f32 v58, v58
    v_mfma_f32_16x16x32_bf16 v[40:43], a[148:151], a[4:7], v[40:43]
    v_exp_f32 v59, v59
    v_mfma_f32_16x16x32_bf16 v[40:43], a[152:155], a[8:11], v[40:43]
    ds_read_b64_tr_b16 a[188:189], v2 offset:25352
    v_cvt_pk_bf16_f32 v92, v56, v57
    v_mfma_f32_16x16x32_bf16 v[40:43], a[156:159], a[12:15], v[40:43]
    buffer_load_dwordx4 v5, s[12:15], s41 offen offset:3072 nt lds
    v_mfma_f32_16x16x32_bf16 v[44:47], a[156:159], a[28:31], v[24:27]
    v_cvt_pk_bf16_f32 v93, v58, v59
    v_mfma_f32_16x16x32_bf16 v[44:47], a[152:155], a[24:27], v[44:47]
    v_mfma_f32_16x16x32_bf16 v[44:47], a[148:151], a[20:23], v[44:47]
    ds_read_b64_tr_b16 a[190:191], v2 offset:29448
    v_mfma_f32_16x16x32_bf16 v[44:47], a[144:147], a[16:19], v[44:47]
    v_mfma_f32_16x16x32_bf16 v[52:55], a[144:147], a[32:35], v[28:31]
    v_exp_f32 v40, v40
    v_mfma_f32_16x16x32_bf16 v[52:55], a[148:151], a[36:39], v[52:55]
    v_exp_f32 v41, v41
    v_mfma_f32_16x16x32_bf16 v[52:55], a[152:155], a[40:43], v[52:55]
    v_exp_f32 v42, v42
    v_mfma_f32_16x16x32_bf16 v[52:55], a[156:159], a[44:47], v[52:55]
    v_exp_f32 v43, v43
    v_mfma_f32_16x16x32_bf16 v[60:63], a[156:159], a[60:63], v[32:35]
    v_cvt_pk_bf16_f32 v82, v40, v41
    v_cvt_pk_bf16_f32 v83, v42, v43
    v_mfma_f32_16x16x32_bf16 v[60:63], a[152:155], a[56:59], v[60:63]
    s_waitcnt lgkmcnt(0)
    v_exp_f32 v44, v44
    v_mfma_f32_16x16x32_bf16 v[60:63], a[148:151], a[52:55], v[60:63]
    s_waitcnt vmcnt(23)
    v_exp_f32 v45, v45
    v_mfma_f32_16x16x32_bf16 v[60:63], a[144:147], a[48:51], v[60:63]
    s_barrier
    v_mfma_f32_16x16x32_bf16 v[224:227], a[176:179], v[96:99], v[224:227]
    s_add_u32 s40, s28, 98304
    ds_read_b128 a[128:131], v1 offset:49152
    v_cvt_pk_bf16_f32 v86, v44, v45
    v_mfma_f32_16x16x32_bf16 v[224:227], a[180:183], v[112:115], v[224:227]
    s_add_u32 s41, s28, 81920
    ds_read_b64_tr_b16 a[160:161], v2 offset:32768
    v_mfma_f32_16x16x32_bf16 v[228:231], a[180:183], v[116:119], v[228:231]
    s_add_u32 m0, s39, 32768
    ds_read_b128 a[132:135], v1 offset:49408
    v_mfma_f32_16x16x32_bf16 v[228:231], a[176:179], v[100:103], v[228:231]
    ds_read_b64_tr_b16 a[162:163], v2 offset:36864
    v_mfma_f32_16x16x32_bf16 v[232:235], a[176:179], v[104:107], v[232:235]
    ds_read_b128 a[136:139], v1 offset:49664
    v_mfma_f32_16x16x32_bf16 v[232:235], a[180:183], v[120:123], v[232:235]
    ds_read_b64_tr_b16 a[164:165], v2 offset:40960
    v_mfma_f32_16x16x32_bf16 v[236:239], a[180:183], v[124:127], v[236:239]
    v_exp_f32 v46, v46
    v_mfma_f32_16x16x32_bf16 v[236:239], a[176:179], v[108:111], v[236:239]
    buffer_load_dwordx4 v5, s[8:11], s40 offen offset:0 nt lds
    v_mfma_f32_16x16x32_bf16 v[240:243], a[184:187], v[96:99], v[240:243]
    ds_read_b128 a[140:143], v1 offset:49920
    v_mfma_f32_16x16x32_bf16 v[240:243], a[188:191], v[112:115], v[240:243]
    ds_read_b64_tr_b16 a[166:167], v2 offset:45056
    v_mfma_f32_16x16x32_bf16 v[244:247], a[188:191], v[116:119], v[244:247]
    v_exp_f32 v47, v47
    v_mfma_f32_16x16x32_bf16 v[244:247], a[184:187], v[100:103], v[244:247]
    v_exp_f32 v52, v52
    v_mfma_f32_16x16x32_bf16 v[248:251], a[184:187], v[104:107], v[248:251]
    ds_read_b64_tr_b16 a[168:169], v2 offset:32776
    v_cvt_pk_bf16_f32 v87, v46, v47
    v_mfma_f32_16x16x32_bf16 v[248:251], a[188:191], v[120:123], v[248:251]
    s_add_u32 m0, s66, 4096
    v_exp_f32 v53, v53
    v_mfma_f32_16x16x32_bf16 v[252:255], a[188:191], v[124:127], v[252:255]
    v_exp_f32 v54, v54
    v_mfma_f32_16x16x32_bf16 v[252:255], a[184:187], v[108:111], v[252:255]
    v_exp_f32 v55, v55
    v_mfma_f32_16x16x32_bf16 a[204:207], a[208:211], v[108:111], a[204:207]
    s_waitcnt lgkmcnt(2)
    ds_read_b64_tr_b16 a[170:171], v2 offset:36872
    v_cvt_pk_bf16_f32 v90, v52, v53
    v_mfma_f32_16x16x32_bf16 a[204:207], a[208:211], v[124:127], a[204:207]
    v_exp_f32 v60, v60
    v_mfma_f32_16x16x32_bf16 v[40:43], a[128:131], a[0:3], v[20:23]
    v_exp_f32 v61, v61
    v_mfma_f32_16x16x32_bf16 v[40:43], a[132:135], a[4:7], v[40:43]
    v_cvt_pk_bf16_f32 v91, v54, v55
    v_cvt_pk_bf16_f32 v94, v60, v61
    v_mfma_f32_16x16x32_bf16 v[40:43], a[136:139], a[8:11], v[40:43]
    ds_read_b64_tr_b16 a[172:173], v2 offset:40968
    v_mfma_f32_16x16x32_bf16 v[40:43], a[140:143], a[12:15], v[40:43]
    buffer_load_dwordx4 v7, s[4:7], s31 offen offset:2048 nt lds
    v_mfma_f32_16x16x32_bf16 v[44:47], a[140:143], a[28:31], v[24:27]
    v_exp_f32 v62, v62
    v_mfma_f32_16x16x32_bf16 v[44:47], a[136:139], a[24:27], v[44:47]
    v_exp_f32 v63, v63
    v_mfma_f32_16x16x32_bf16 v[44:47], a[132:135], a[20:23], v[44:47]
    ds_read_b64_tr_b16 a[174:175], v2 offset:45064
    v_cvt_pk_bf16_f32 v95, v62, v63
    v_mfma_f32_16x16x32_bf16 v[44:47], a[128:131], a[16:19], v[44:47]
    v_exp_f32 v40, v40
    v_mfma_f32_16x16x32_bf16 v[48:51], a[128:131], a[32:35], v[28:31]
    s_add_u32 m0, s39, 32768
    v_exp_f32 v41, v41
    v_mfma_f32_16x16x32_bf16 v[48:51], a[132:135], a[36:39], v[48:51]
    v_exp_f32 v42, v42
    v_mfma_f32_16x16x32_bf16 v[48:51], a[136:139], a[40:43], v[48:51]
    v_exp_f32 v43, v43
    v_mfma_f32_16x16x32_bf16 v[48:51], a[140:143], a[44:47], v[48:51]
    v_cvt_pk_bf16_f32 v96, v40, v41
    v_cvt_pk_bf16_f32 v97, v42, v43
    v_mfma_f32_16x16x32_bf16 v[56:59], a[140:143], a[60:63], v[32:35]
    ds_read_b128 a[144:147], v1 offset:53248
    v_mfma_f32_16x16x32_bf16 v[56:59], a[136:139], a[56:59], v[56:59]
    ds_read_b64_tr_b16 a[176:177], v2 offset:33024
    v_mfma_f32_16x16x32_bf16 v[56:59], a[132:135], a[52:55], v[56:59]
    s_waitcnt lgkmcnt(2)
    v_exp_f32 v44, v44
    v_mfma_f32_16x16x32_bf16 v[56:59], a[128:131], a[48:51], v[56:59]
    buffer_load_dwordx4 v6, s[8:11], s40 offen offset:1024 nt lds
    v_mfma_f32_16x16x32_bf16 v[128:131], a[160:163], v[64:67], v[128:131]
    ds_read_b128 a[148:151], v1 offset:53504
    v_mfma_f32_16x16x32_bf16 v[128:131], a[164:167], v[80:83], v[128:131]
    ds_read_b64_tr_b16 a[178:179], v2 offset:37120
    v_mfma_f32_16x16x32_bf16 v[132:135], a[164:167], v[84:87], v[132:135]
    v_exp_f32 v45, v45
    v_mfma_f32_16x16x32_bf16 v[132:135], a[160:163], v[68:71], v[132:135]
    buffer_store_dwordx4 a[220:223], v3, s[72:75], s77 offen offset:128 nt
    v_mfma_f32_16x16x32_bf16 v[136:139], a[160:163], v[72:75], v[136:139]
    ds_read_b128 a[152:155], v1 offset:53760
    v_cvt_pk_bf16_f32 v100, v44, v45
    v_mfma_f32_16x16x32_bf16 v[136:139], a[164:167], v[88:91], v[136:139]
    ds_read_b64_tr_b16 a[180:181], v2 offset:41216
    v_mfma_f32_16x16x32_bf16 v[140:143], a[164:167], v[92:95], v[140:143]
    v_exp_f32 v46, v46
    v_mfma_f32_16x16x32_bf16 v[140:143], a[160:163], v[76:79], v[140:143]
    v_exp_f32 v47, v47
    v_mfma_f32_16x16x32_bf16 v[144:147], a[168:171], v[64:67], v[144:147]
    ds_read_b128 a[156:159], v1 offset:54016
    v_cvt_pk_bf16_f32 v101, v46, v47
    v_mfma_f32_16x16x32_bf16 v[144:147], a[172:175], v[80:83], v[144:147]
    ds_read_b64_tr_b16 a[182:183], v2 offset:45312
    v_mfma_f32_16x16x32_bf16 v[148:151], a[172:175], v[84:87], v[148:151]
    v_exp_f32 v48, v48
    v_mfma_f32_16x16x32_bf16 v[148:151], a[168:171], v[68:71], v[148:151]
    buffer_load_dwordx4 v7, s[8:11], s40 offen offset:2048 nt lds
    v_mfma_f32_16x16x32_bf16 v[152:155], a[168:171], v[72:75], v[152:155]
    ds_read_b64_tr_b16 a[184:185], v2 offset:33032
    v_mfma_f32_16x16x32_bf16 v[152:155], a[172:175], v[88:91], v[152:155]
    v_exp_f32 v49, v49
    v_mfma_f32_16x16x32_bf16 v[156:159], a[172:175], v[92:95], v[156:159]
    v_exp_f32 v50, v50
    v_mfma_f32_16x16x32_bf16 v[156:159], a[168:171], v[76:79], v[156:159]
    v_exp_f32 v51, v51
    v_mfma_f32_16x16x32_bf16 a[192:195], a[208:211], v[64:67], a[192:195]
    s_waitcnt lgkmcnt(2)
    ds_read_b64_tr_b16 a[186:187], v2 offset:37128
    v_cvt_pk_bf16_f32 v104, v48, v49
    v_mfma_f32_16x16x32_bf16 a[192:195], a[208:211], v[80:83], a[192:195]
    s_add_u32 m0, s66, 4096
    v_exp_f32 v56, v56
    v_mfma_f32_16x16x32_bf16 v[40:43], a[144:147], a[0:3], v[20:23]
    v_exp_f32 v57, v57
    v_mfma_f32_16x16x32_bf16 v[40:43], a[148:151], a[4:7], v[40:43]
    v_cvt_pk_bf16_f32 v105, v50, v51
    v_cvt_pk_bf16_f32 v108, v56, v57
    v_mfma_f32_16x16x32_bf16 v[40:43], a[152:155], a[8:11], v[40:43]
    ds_read_b64_tr_b16 a[188:189], v2 offset:41224
    v_mfma_f32_16x16x32_bf16 v[40:43], a[156:159], a[12:15], v[40:43]
    v_exp_f32 v58, v58
    v_mfma_f32_16x16x32_bf16 v[44:47], a[156:159], a[28:31], v[24:27]
    v_exp_f32 v59, v59
    v_mfma_f32_16x16x32_bf16 v[44:47], a[152:155], a[24:27], v[44:47]
    v_cvt_pk_bf16_f32 v109, v58, v59
    v_mfma_f32_16x16x32_bf16 v[44:47], a[148:151], a[20:23], v[44:47]
    ds_read_b64_tr_b16 a[190:191], v2 offset:45320
    v_mfma_f32_16x16x32_bf16 v[44:47], a[144:147], a[16:19], v[44:47]
    buffer_load_dwordx4 v8, s[4:7], s31 offen offset:3072 nt lds
    v_mfma_f32_16x16x32_bf16 v[52:55], a[144:147], a[32:35], v[28:31]
    v_exp_f32 v40, v40
    v_mfma_f32_16x16x32_bf16 v[52:55], a[148:151], a[36:39], v[52:55]
    v_exp_f32 v41, v41
    v_mfma_f32_16x16x32_bf16 v[52:55], a[152:155], a[40:43], v[52:55]
    v_exp_f32 v42, v42
    v_mfma_f32_16x16x32_bf16 v[52:55], a[156:159], a[44:47], v[52:55]
    v_exp_f32 v43, v43
    v_mfma_f32_16x16x32_bf16 v[60:63], a[156:159], a[60:63], v[32:35]
    s_add_u32 m0, s39, 32768
    ds_read_b128 a[128:131], v1 offset:57344
    v_cvt_pk_bf16_f32 v98, v40, v41
    v_mfma_f32_16x16x32_bf16 v[60:63], a[152:155], a[56:59], v[60:63]
    ds_read_b64_tr_b16 a[160:161], v2 offset:33280
    v_cvt_pk_bf16_f32 v99, v42, v43
    v_mfma_f32_16x16x32_bf16 v[60:63], a[148:151], a[52:55], v[60:63]
    s_waitcnt lgkmcnt(2)
    v_exp_f32 v44, v44
    v_mfma_f32_16x16x32_bf16 v[60:63], a[144:147], a[48:51], v[60:63]
    v_exp_f32 v45, v45
    v_mfma_f32_16x16x32_bf16 v[160:163], a[176:179], v[64:67], v[160:163]
    ds_read_b128 a[132:135], v1 offset:57600
    v_cvt_pk_bf16_f32 v102, v44, v45
    v_mfma_f32_16x16x32_bf16 v[160:163], a[180:183], v[80:83], v[160:163]
    ds_read_b64_tr_b16 a[162:163], v2 offset:37376
    v_mfma_f32_16x16x32_bf16 v[164:167], a[180:183], v[84:87], v[164:167]
    v_exp_f32 v46, v46
    v_mfma_f32_16x16x32_bf16 v[164:167], a[176:179], v[68:71], v[164:167]
    buffer_load_dwordx4 v8, s[8:11], s40 offen offset:3072 nt lds
    v_mfma_f32_16x16x32_bf16 v[168:171], a[176:179], v[72:75], v[168:171]
    ds_read_b128 a[136:139], v1 offset:57856
    v_mfma_f32_16x16x32_bf16 v[168:171], a[180:183], v[88:91], v[168:171]
    ds_read_b64_tr_b16 a[164:165], v2 offset:41472
    v_mfma_f32_16x16x32_bf16 v[172:175], a[180:183], v[92:95], v[172:175]
    v_exp_f32 v47, v47
    v_mfma_f32_16x16x32_bf16 v[172:175], a[176:179], v[76:79], v[172:175]
    v_exp_f32 v52, v52
    v_mfma_f32_16x16x32_bf16 v[176:179], a[184:187], v[64:67], v[176:179]
    ds_read_b128 a[140:143], v1 offset:58112
    v_cvt_pk_bf16_f32 v103, v46, v47
    v_mfma_f32_16x16x32_bf16 v[176:179], a[188:191], v[80:83], v[176:179]
    s_add_u32 m0, s39, 81920
    ds_read_b64_tr_b16 a[166:167], v2 offset:45568
    v_mfma_f32_16x16x32_bf16 v[180:183], a[188:191], v[84:87], v[180:183]
    v_exp_f32 v53, v53
    v_mfma_f32_16x16x32_bf16 v[180:183], a[184:187], v[68:71], v[180:183]
    v_exp_f32 v54, v54
    v_mfma_f32_16x16x32_bf16 v[184:187], a[184:187], v[72:75], v[184:187]
    ds_read_b64_tr_b16 a[168:169], v2 offset:33288
    v_cvt_pk_bf16_f32 v106, v52, v53
    v_mfma_f32_16x16x32_bf16 v[184:187], a[188:191], v[88:91], v[184:187]
    v_exp_f32 v55, v55
    v_mfma_f32_16x16x32_bf16 v[188:191], a[188:191], v[92:95], v[188:191]
    v_exp_f32 v60, v60
    v_mfma_f32_16x16x32_bf16 v[188:191], a[184:187], v[76:79], v[188:191]
    buffer_load_dwordx4 v5, s[12:15], s41 offen offset:0 nt lds
    v_mfma_f32_16x16x32_bf16 a[196:199], a[208:211], v[68:71], a[196:199]
    s_waitcnt lgkmcnt(2)
    ds_read_b64_tr_b16 a[170:171], v2 offset:37384
    v_cvt_pk_bf16_f32 v107, v54, v55
    v_mfma_f32_16x16x32_bf16 a[196:199], a[208:211], v[84:87], a[196:199]
    v_exp_f32 v61, v61
    v_mfma_f32_16x16x32_bf16 v[40:43], a[128:131], a[0:3], v[20:23]
    v_exp_f32 v62, v62
    v_mfma_f32_16x16x32_bf16 v[40:43], a[132:135], a[4:7], v[40:43]
    v_exp_f32 v63, v63
    v_mfma_f32_16x16x32_bf16 v[40:43], a[136:139], a[8:11], v[40:43]
    ds_read_b64_tr_b16 a[172:173], v2 offset:41480
    v_cvt_pk_bf16_f32 v110, v60, v61
    v_mfma_f32_16x16x32_bf16 v[40:43], a[140:143], a[12:15], v[40:43]
    v_cvt_pk_bf16_f32 v111, v62, v63
    v_mfma_f32_16x16x32_bf16 v[44:47], a[140:143], a[28:31], v[24:27]
    v_mfma_f32_16x16x32_bf16 v[44:47], a[136:139], a[24:27], v[44:47]
    v_mfma_f32_16x16x32_bf16 v[44:47], a[132:135], a[20:23], v[44:47]
    ds_read_b64_tr_b16 a[174:175], v2 offset:45576
    v_mfma_f32_16x16x32_bf16 v[44:47], a[128:131], a[16:19], v[44:47]
    v_mfma_f32_16x16x32_bf16 v[48:51], a[128:131], a[32:35], v[28:31]
    v_mfma_f32_16x16x32_bf16 v[48:51], a[132:135], a[36:39], v[48:51]
    v_exp_f32 v40, v40
    v_mfma_f32_16x16x32_bf16 v[48:51], a[136:139], a[40:43], v[48:51]
    v_exp_f32 v41, v41
    v_mfma_f32_16x16x32_bf16 v[48:51], a[140:143], a[44:47], v[48:51]
    buffer_load_dwordx4 v5, s[12:15], s41 offen offset:1024 nt lds
    v_mfma_f32_16x16x32_bf16 v[56:59], a[140:143], a[60:63], v[32:35]
    ds_read_b128 a[144:147], v1 offset:61440
    v_cvt_pk_bf16_f32 v112, v40, v41
    v_mfma_f32_16x16x32_bf16 v[56:59], a[136:139], a[56:59], v[56:59]
    ds_read_b64_tr_b16 a[176:177], v2 offset:33536
    v_mfma_f32_16x16x32_bf16 v[56:59], a[132:135], a[52:55], v[56:59]
    s_waitcnt lgkmcnt(2)
    v_exp_f32 v42, v42
    v_mfma_f32_16x16x32_bf16 v[56:59], a[128:131], a[48:51], v[56:59]
    v_exp_f32 v43, v43
    v_mfma_f32_16x16x32_bf16 v[192:195], a[160:163], v[64:67], v[192:195]
    ds_read_b128 a[148:151], v1 offset:61696
    v_cvt_pk_bf16_f32 v113, v42, v43
    v_mfma_f32_16x16x32_bf16 v[192:195], a[164:167], v[80:83], v[192:195]
    buffer_store_dwordx4 a[224:227], v3, s[72:75], s77 offen offset:2176 nt
    v_mfma_f32_16x16x32_bf16 v[196:199], a[164:167], v[84:87], v[196:199]
    ds_read_b64_tr_b16 a[178:179], v2 offset:37632
    v_mfma_f32_16x16x32_bf16 v[196:199], a[160:163], v[68:71], v[196:199]
    v_exp_f32 v44, v44
    v_mfma_f32_16x16x32_bf16 v[200:203], a[160:163], v[72:75], v[200:203]
    ds_read_b128 a[152:155], v1 offset:61952
    v_mfma_f32_16x16x32_bf16 v[200:203], a[164:167], v[88:91], v[200:203]
    ds_read_b64_tr_b16 a[180:181], v2 offset:41728
    v_mfma_f32_16x16x32_bf16 v[204:207], a[164:167], v[92:95], v[204:207]
    v_exp_f32 v45, v45
    v_mfma_f32_16x16x32_bf16 v[204:207], a[160:163], v[76:79], v[204:207]
    buffer_load_dwordx4 v5, s[12:15], s41 offen offset:2048 nt lds
    v_mfma_f32_16x16x32_bf16 v[208:211], a[168:171], v[64:67], v[208:211]
    ds_read_b128 a[156:159], v1 offset:62208
    v_cvt_pk_bf16_f32 v116, v44, v45
    v_mfma_f32_16x16x32_bf16 v[208:211], a[172:175], v[80:83], v[208:211]
    ds_read_b64_tr_b16 a[182:183], v2 offset:45824
    v_mfma_f32_16x16x32_bf16 v[212:215], a[172:175], v[84:87], v[212:215]
    v_exp_f32 v46, v46
    v_mfma_f32_16x16x32_bf16 v[212:215], a[168:171], v[68:71], v[212:215]
    v_exp_f32 v47, v47
    v_mfma_f32_16x16x32_bf16 v[216:219], a[168:171], v[72:75], v[216:219]
    ds_read_b64_tr_b16 a[184:185], v2 offset:33544
    v_cvt_pk_bf16_f32 v117, v46, v47
    v_mfma_f32_16x16x32_bf16 v[216:219], a[172:175], v[88:91], v[216:219]
    v_exp_f32 v48, v48
    v_mfma_f32_16x16x32_bf16 v[220:223], a[172:175], v[92:95], v[220:223]
    v_exp_f32 v49, v49
    v_mfma_f32_16x16x32_bf16 v[220:223], a[168:171], v[76:79], v[220:223]
    v_exp_f32 v50, v50
    v_mfma_f32_16x16x32_bf16 a[200:203], a[208:211], v[72:75], a[200:203]
    s_waitcnt lgkmcnt(2)
    ds_read_b64_tr_b16 a[186:187], v2 offset:37640
    v_cvt_pk_bf16_f32 v120, v48, v49
    v_mfma_f32_16x16x32_bf16 a[200:203], a[208:211], v[88:91], a[200:203]
    v_exp_f32 v51, v51
    v_mfma_f32_16x16x32_bf16 v[40:43], a[144:147], a[0:3], v[20:23]
    v_exp_f32 v56, v56
    v_mfma_f32_16x16x32_bf16 v[40:43], a[148:151], a[4:7], v[40:43]
    v_exp_f32 v57, v57
    v_mfma_f32_16x16x32_bf16 v[40:43], a[152:155], a[8:11], v[40:43]
    ds_read_b64_tr_b16 a[188:189], v2 offset:41736
    v_cvt_pk_bf16_f32 v121, v50, v51
    v_mfma_f32_16x16x32_bf16 v[40:43], a[156:159], a[12:15], v[40:43]
    buffer_load_dwordx4 v5, s[12:15], s41 offen offset:3072 nt lds
    v_mfma_f32_16x16x32_bf16 v[44:47], a[156:159], a[28:31], v[24:27]
    v_exp_f32 v58, v58
    v_mfma_f32_16x16x32_bf16 v[44:47], a[152:155], a[24:27], v[44:47]
    v_exp_f32 v59, v59
    v_mfma_f32_16x16x32_bf16 v[44:47], a[148:151], a[20:23], v[44:47]
    ds_read_b64_tr_b16 a[190:191], v2 offset:45832
    v_cvt_pk_bf16_f32 v124, v56, v57
    v_mfma_f32_16x16x32_bf16 v[44:47], a[144:147], a[16:19], v[44:47]
    v_exp_f32 v40, v40
    v_mfma_f32_16x16x32_bf16 v[52:55], a[144:147], a[32:35], v[28:31]
    v_exp_f32 v41, v41
    v_mfma_f32_16x16x32_bf16 v[52:55], a[148:151], a[36:39], v[52:55]
    v_exp_f32 v42, v42
    v_mfma_f32_16x16x32_bf16 v[52:55], a[152:155], a[40:43], v[52:55]
    v_exp_f32 v43, v43
    v_mfma_f32_16x16x32_bf16 v[52:55], a[156:159], a[44:47], v[52:55]
    v_cvt_pk_bf16_f32 v114, v40, v41
    v_cvt_pk_bf16_f32 v115, v42, v43
    v_mfma_f32_16x16x32_bf16 v[60:63], a[156:159], a[60:63], v[32:35]
    v_exp_f32 v44, v44
    v_mfma_f32_16x16x32_bf16 v[60:63], a[152:155], a[56:59], v[60:63]
    s_waitcnt lgkmcnt(0)
    v_exp_f32 v45, v45
    v_mfma_f32_16x16x32_bf16 v[60:63], a[148:151], a[52:55], v[60:63]
    s_waitcnt vmcnt(24)
    v_exp_f32 v46, v46
    v_mfma_f32_16x16x32_bf16 v[60:63], a[144:147], a[48:51], v[60:63]
    s_barrier
    v_mfma_f32_16x16x32_bf16 v[224:227], a[176:179], v[64:67], v[224:227]
    s_add_u32 s40, s28, 114688
    ds_read_b128 a[128:131], v1 offset:0
    v_cvt_pk_bf16_f32 v118, v44, v45
    v_mfma_f32_16x16x32_bf16 v[224:227], a[180:183], v[80:83], v[224:227]
    s_add_u32 s41, s28, 98304
    ds_read_b64_tr_b16 a[160:161], v2 offset:49152
    v_cvt_pk_bf16_f32 v125, v58, v59
    v_mfma_f32_16x16x32_bf16 v[228:231], a[180:183], v[84:87], v[228:231]
    s_add_u32 m0, s39, 49152
    ds_read_b128 a[132:135], v1 offset:256
    v_mfma_f32_16x16x32_bf16 v[228:231], a[176:179], v[68:71], v[228:231]
    ds_read_b64_tr_b16 a[162:163], v2 offset:53248
    v_mfma_f32_16x16x32_bf16 v[232:235], a[176:179], v[72:75], v[232:235]
    ds_read_b128 a[136:139], v1 offset:512
    v_mfma_f32_16x16x32_bf16 v[232:235], a[180:183], v[88:91], v[232:235]
    ds_read_b64_tr_b16 a[164:165], v2 offset:57344
    v_mfma_f32_16x16x32_bf16 v[236:239], a[180:183], v[92:95], v[236:239]
    v_exp_f32 v47, v47
    v_mfma_f32_16x16x32_bf16 v[236:239], a[176:179], v[76:79], v[236:239]
    buffer_load_dwordx4 v5, s[8:11], s40 offen offset:0 nt lds
    v_mfma_f32_16x16x32_bf16 v[240:243], a[184:187], v[64:67], v[240:243]
    ds_read_b128 a[140:143], v1 offset:768
    v_cvt_pk_bf16_f32 v119, v46, v47
    v_mfma_f32_16x16x32_bf16 v[240:243], a[188:191], v[80:83], v[240:243]
    ds_read_b64_tr_b16 a[166:167], v2 offset:61440
    v_mfma_f32_16x16x32_bf16 v[244:247], a[188:191], v[84:87], v[244:247]
    v_exp_f32 v52, v52
    v_mfma_f32_16x16x32_bf16 v[244:247], a[184:187], v[68:71], v[244:247]
    v_exp_f32 v53, v53
    v_mfma_f32_16x16x32_bf16 v[248:251], a[184:187], v[72:75], v[248:251]
    ds_read_b64_tr_b16 a[168:169], v2 offset:49160
    v_cvt_pk_bf16_f32 v122, v52, v53
    v_mfma_f32_16x16x32_bf16 v[248:251], a[188:191], v[88:91], v[248:251]
    v_exp_f32 v54, v54
    v_mfma_f32_16x16x32_bf16 v[252:255], a[188:191], v[92:95], v[252:255]
    v_exp_f32 v55, v55
    v_mfma_f32_16x16x32_bf16 v[252:255], a[184:187], v[76:79], v[252:255]
    v_exp_f32 v60, v60
    v_mfma_f32_16x16x32_bf16 a[204:207], a[208:211], v[76:79], a[204:207]
    s_waitcnt lgkmcnt(2)
    ds_read_b64_tr_b16 a[170:171], v2 offset:53256
    v_cvt_pk_bf16_f32 v123, v54, v55
    v_mfma_f32_16x16x32_bf16 a[204:207], a[208:211], v[92:95], a[204:207]
    v_exp_f32 v61, v61
    v_mfma_f32_16x16x32_bf16 v[40:43], a[128:131], a[0:3], v[20:23]
    v_exp_f32 v62, v62
    v_mfma_f32_16x16x32_bf16 v[40:43], a[132:135], a[4:7], v[40:43]
    v_exp_f32 v63, v63
    v_mfma_f32_16x16x32_bf16 v[40:43], a[136:139], a[8:11], v[40:43]
    ds_read_b64_tr_b16 a[172:173], v2 offset:57352
    v_cvt_pk_bf16_f32 v126, v60, v61
    v_mfma_f32_16x16x32_bf16 v[40:43], a[140:143], a[12:15], v[40:43]
    buffer_load_dwordx4 v6, s[8:11], s40 offen offset:1024 nt lds
    v_mfma_f32_16x16x32_bf16 v[44:47], a[140:143], a[28:31], v[24:27]
    v_cvt_pk_bf16_f32 v127, v62, v63
    v_mfma_f32_16x16x32_bf16 v[44:47], a[136:139], a[24:27], v[44:47]
    v_mfma_f32_16x16x32_bf16 v[44:47], a[132:135], a[20:23], v[44:47]
    ds_read_b64_tr_b16 a[174:175], v2 offset:61448
    v_mfma_f32_16x16x32_bf16 v[44:47], a[128:131], a[16:19], v[44:47]
    v_mfma_f32_16x16x32_bf16 v[48:51], a[128:131], a[32:35], v[28:31]
    v_exp_f32 v40, v40
    v_mfma_f32_16x16x32_bf16 v[48:51], a[132:135], a[36:39], v[48:51]
    v_exp_f32 v41, v41
    v_mfma_f32_16x16x32_bf16 v[48:51], a[136:139], a[40:43], v[48:51]
    v_exp_f32 v42, v42
    v_mfma_f32_16x16x32_bf16 v[48:51], a[140:143], a[44:47], v[48:51]
    v_exp_f32 v43, v43
    v_mfma_f32_16x16x32_bf16 v[56:59], a[140:143], a[60:63], v[32:35]
    ds_read_b128 a[144:147], v1 offset:4096
    v_cvt_pk_bf16_f32 v64, v40, v41
    v_mfma_f32_16x16x32_bf16 v[56:59], a[136:139], a[56:59], v[56:59]
    ds_read_b64_tr_b16 a[176:177], v2 offset:49408
    v_cvt_pk_bf16_f32 v65, v42, v43
    v_mfma_f32_16x16x32_bf16 v[56:59], a[132:135], a[52:55], v[56:59]
    s_waitcnt lgkmcnt(2)
    v_exp_f32 v44, v44
    v_mfma_f32_16x16x32_bf16 v[56:59], a[128:131], a[48:51], v[56:59]
    buffer_load_dwordx4 v7, s[8:11], s40 offen offset:2048 nt lds
    v_mfma_f32_16x16x32_bf16 v[128:131], a[160:163], v[96:99], v[128:131]
    ds_read_b128 a[148:151], v1 offset:4352
    v_mfma_f32_16x16x32_bf16 v[128:131], a[164:167], v[112:115], v[128:131]
    ds_read_b64_tr_b16 a[178:179], v2 offset:53504
    v_mfma_f32_16x16x32_bf16 v[132:135], a[164:167], v[116:119], v[132:135]
    v_exp_f32 v45, v45
    v_mfma_f32_16x16x32_bf16 v[132:135], a[160:163], v[100:103], v[132:135]
    buffer_store_dwordx4 a[228:231], v4, s[72:75], s76 offen offset:128 nt
    v_mfma_f32_16x16x32_bf16 v[136:139], a[160:163], v[104:107], v[136:139]
    ds_read_b128 a[152:155], v1 offset:4608
    v_cvt_pk_bf16_f32 v68, v44, v45
    v_mfma_f32_16x16x32_bf16 v[136:139], a[164:167], v[120:123], v[136:139]
    ds_read_b64_tr_b16 a[180:181], v2 offset:57600
    v_mfma_f32_16x16x32_bf16 v[140:143], a[164:167], v[124:127], v[140:143]
    v_exp_f32 v46, v46
    v_mfma_f32_16x16x32_bf16 v[140:143], a[160:163], v[108:111], v[140:143]
    v_exp_f32 v47, v47
    v_mfma_f32_16x16x32_bf16 v[144:147], a[168:171], v[96:99], v[144:147]
    ds_read_b128 a[156:159], v1 offset:4864
    v_cvt_pk_bf16_f32 v69, v46, v47
    v_mfma_f32_16x16x32_bf16 v[144:147], a[172:175], v[112:115], v[144:147]
    ds_read_b64_tr_b16 a[182:183], v2 offset:61696
    v_mfma_f32_16x16x32_bf16 v[148:151], a[172:175], v[116:119], v[148:151]
    v_exp_f32 v48, v48
    v_mfma_f32_16x16x32_bf16 v[148:151], a[168:171], v[100:103], v[148:151]
    buffer_load_dwordx4 v8, s[8:11], s40 offen offset:3072 nt lds
    v_mfma_f32_16x16x32_bf16 v[152:155], a[168:171], v[104:107], v[152:155]
    ds_read_b64_tr_b16 a[184:185], v2 offset:49416
    v_mfma_f32_16x16x32_bf16 v[152:155], a[172:175], v[120:123], v[152:155]
    v_exp_f32 v49, v49
    v_mfma_f32_16x16x32_bf16 v[156:159], a[172:175], v[124:127], v[156:159]
    s_waitcnt vmcnt(26)
    v_exp_f32 v50, v50
    v_mfma_f32_16x16x32_bf16 v[156:159], a[168:171], v[108:111], v[156:159]
    v_exp_f32 v51, v51
    v_mfma_f32_16x16x32_bf16 a[192:195], a[208:211], v[96:99], a[192:195]
    s_waitcnt lgkmcnt(2)
    ds_read_b64_tr_b16 a[186:187], v2 offset:53512
    v_cvt_pk_bf16_f32 v72, v48, v49
    v_mfma_f32_16x16x32_bf16 a[192:195], a[208:211], v[112:115], a[192:195]
    s_add_u32 m0, s39, 98304
    v_exp_f32 v56, v56
    v_mfma_f32_16x16x32_bf16 v[40:43], a[144:147], a[0:3], v[20:23]
    v_exp_f32 v57, v57
    v_mfma_f32_16x16x32_bf16 v[40:43], a[148:151], a[4:7], v[40:43]
    v_cvt_pk_bf16_f32 v73, v50, v51
    v_cvt_pk_bf16_f32 v76, v56, v57
    v_mfma_f32_16x16x32_bf16 v[40:43], a[152:155], a[8:11], v[40:43]
    ds_read_b64_tr_b16 a[188:189], v2 offset:57608
    v_mfma_f32_16x16x32_bf16 v[40:43], a[156:159], a[12:15], v[40:43]
    v_exp_f32 v58, v58
    v_mfma_f32_16x16x32_bf16 v[44:47], a[156:159], a[28:31], v[24:27]
    v_exp_f32 v59, v59
    v_mfma_f32_16x16x32_bf16 v[44:47], a[152:155], a[24:27], v[44:47]
    v_cvt_pk_bf16_f32 v77, v58, v59
    v_mfma_f32_16x16x32_bf16 v[44:47], a[148:151], a[20:23], v[44:47]
    ds_read_b64_tr_b16 a[190:191], v2 offset:61704
    v_mfma_f32_16x16x32_bf16 v[44:47], a[144:147], a[16:19], v[44:47]
    buffer_load_dwordx4 v5, s[12:15], s41 offen offset:0 nt lds
    v_mfma_f32_16x16x32_bf16 v[52:55], a[144:147], a[32:35], v[28:31]
    ds_read_b128 a[64:67], v9 offset:0
    v_mfma_f32_16x16x32_bf16 v[52:55], a[148:151], a[36:39], v[52:55]
    v_exp_f32 v40, v40
    v_mfma_f32_16x16x32_bf16 v[52:55], a[152:155], a[40:43], v[52:55]
    v_exp_f32 v41, v41
    v_mfma_f32_16x16x32_bf16 v[52:55], a[156:159], a[44:47], v[52:55]
    v_exp_f32 v42, v42
    v_mfma_f32_16x16x32_bf16 v[60:63], a[156:159], a[60:63], v[32:35]
    ds_read_b128 a[68:71], v9 offset:256
    v_cvt_pk_bf16_f32 v66, v40, v41
    v_mfma_f32_16x16x32_bf16 v[60:63], a[152:155], a[56:59], v[60:63]
    ds_read_b128 a[128:131], v1 offset:8192
    v_mfma_f32_16x16x32_bf16 v[60:63], a[148:151], a[52:55], v[60:63]
    s_waitcnt lgkmcnt(3)
    ds_read_b64_tr_b16 a[160:161], v2 offset:49664
    v_mfma_f32_16x16x32_bf16 v[60:63], a[144:147], a[48:51], v[60:63]
    v_exp_f32 v43, v43
    v_mfma_f32_16x16x32_bf16 v[160:163], a[176:179], v[96:99], v[160:163]
    ds_read_b128 a[72:75], v9 offset:512
    v_cvt_pk_bf16_f32 v67, v42, v43
    v_mfma_f32_16x16x32_bf16 v[160:163], a[180:183], v[112:115], v[160:163]
    ds_read_b128 a[132:135], v1 offset:8448
    v_mfma_f32_16x16x32_bf16 v[164:167], a[180:183], v[116:119], v[164:167]
    ds_read_b64_tr_b16 a[162:163], v2 offset:53760
    v_mfma_f32_16x16x32_bf16 v[164:167], a[176:179], v[100:103], v[164:167]
    buffer_load_dwordx4 v5, s[12:15], s41 offen offset:1024 nt lds
    v_mfma_f32_16x16x32_bf16 v[168:171], a[176:179], v[104:107], v[168:171]
    ds_read_b128 a[76:79], v9 offset:768
    v_mfma_f32_16x16x32_bf16 v[168:171], a[180:183], v[120:123], v[168:171]
    ds_read_b128 a[136:139], v1 offset:8704
    v_mfma_f32_16x16x32_bf16 v[172:175], a[180:183], v[124:127], v[172:175]
    ds_read_b64_tr_b16 a[164:165], v2 offset:57856
    v_mfma_f32_16x16x32_bf16 v[172:175], a[176:179], v[108:111], v[172:175]
    v_exp_f32 v44, v44
    v_mfma_f32_16x16x32_bf16 v[176:179], a[184:187], v[96:99], v[176:179]
    ds_read_b128 a[140:143], v1 offset:8960
    v_mfma_f32_16x16x32_bf16 v[176:179], a[188:191], v[112:115], v[176:179]
    s_add_u32 m0, s66, 0
    ds_read_b64_tr_b16 a[166:167], v2 offset:61952
    v_mfma_f32_16x16x32_bf16 v[180:183], a[188:191], v[116:119], v[180:183]
    v_exp_f32 v45, v45
    v_mfma_f32_16x16x32_bf16 v[180:183], a[184:187], v[100:103], v[180:183]
    v_exp_f32 v46, v46
    v_mfma_f32_16x16x32_bf16 v[184:187], a[184:187], v[104:107], v[184:187]
    ds_read_b64_tr_b16 a[168:169], v2 offset:49672
    v_cvt_pk_bf16_f32 v70, v44, v45
    v_mfma_f32_16x16x32_bf16 v[184:187], a[188:191], v[120:123], v[184:187]
    v_exp_f32 v47, v47
    v_mfma_f32_16x16x32_bf16 v[188:191], a[188:191], v[124:127], v[188:191]
    v_exp_f32 v52, v52
    v_mfma_f32_16x16x32_bf16 v[188:191], a[184:187], v[108:111], v[188:191]
    s_waitcnt lgkmcnt(5)
    buffer_load_dwordx4 v5, s[68:71], s64 offen offset:0 nt lds
    v_mfma_f32_16x16x32_bf16 a[196:199], a[208:211], v[100:103], a[196:199]
    s_waitcnt lgkmcnt(2)
    ds_read_b64_tr_b16 a[170:171], v2 offset:53768
    v_cvt_pk_bf16_f32 v71, v46, v47
    v_mfma_f32_16x16x32_bf16 a[196:199], a[208:211], v[116:119], a[196:199]
    v_exp_f32 v53, v53
    v_mfma_f32_16x16x32_bf16 v[40:43], a[128:131], a[0:3], v[20:23]
    v_exp_f32 v54, v54
    v_mfma_f32_16x16x32_bf16 v[40:43], a[132:135], a[4:7], v[40:43]
    v_exp_f32 v55, v55
    v_mfma_f32_16x16x32_bf16 v[40:43], a[136:139], a[8:11], v[40:43]
    ds_read_b64_tr_b16 a[172:173], v2 offset:57864
    v_cvt_pk_bf16_f32 v74, v52, v53
    v_mfma_f32_16x16x32_bf16 v[40:43], a[140:143], a[12:15], v[40:43]
    v_exp_f32 v60, v60
    v_mfma_f32_16x16x32_bf16 v[44:47], a[140:143], a[28:31], v[24:27]
    s_add_u32 m0, s39, 98304
    v_exp_f32 v61, v61
    v_mfma_f32_16x16x32_bf16 v[44:47], a[136:139], a[24:27], v[44:47]
    v_cvt_pk_bf16_f32 v75, v54, v55
    v_cvt_pk_bf16_f32 v78, v60, v61
    v_mfma_f32_16x16x32_bf16 v[44:47], a[132:135], a[20:23], v[44:47]
    ds_read_b64_tr_b16 a[174:175], v2 offset:61960
    v_mfma_f32_16x16x32_bf16 v[44:47], a[128:131], a[16:19], v[44:47]
    v_exp_f32 v40, v40
    v_mfma_f32_16x16x32_bf16 v[48:51], a[128:131], a[32:35], v[28:31]
    v_exp_f32 v41, v41
    v_mfma_f32_16x16x32_bf16 v[48:51], a[132:135], a[36:39], v[48:51]
    v_exp_f32 v42, v42
    v_mfma_f32_16x16x32_bf16 v[48:51], a[136:139], a[40:43], v[48:51]
    v_exp_f32 v43, v43
    v_mfma_f32_16x16x32_bf16 v[48:51], a[140:143], a[44:47], v[48:51]
    buffer_load_dwordx4 v5, s[12:15], s41 offen offset:2048 nt lds
    v_mfma_f32_16x16x32_bf16 v[56:59], a[140:143], a[60:63], v[32:35]
    ds_read_b128 a[144:147], v1 offset:12288
    v_cvt_pk_bf16_f32 v80, v40, v41
    v_mfma_f32_16x16x32_bf16 v[56:59], a[136:139], a[56:59], v[56:59]
    ds_read_b64_tr_b16 a[176:177], v2 offset:49920
    v_cvt_pk_bf16_f32 v81, v42, v43
    v_mfma_f32_16x16x32_bf16 v[56:59], a[132:135], a[52:55], v[56:59]
    s_waitcnt lgkmcnt(2)
    v_exp_f32 v44, v44
    v_mfma_f32_16x16x32_bf16 v[56:59], a[128:131], a[48:51], v[56:59]
    v_exp_f32 v45, v45
    v_mfma_f32_16x16x32_bf16 v[192:195], a[160:163], v[96:99], v[192:195]
    ds_read_b128 a[148:151], v1 offset:12544
    v_cvt_pk_bf16_f32 v84, v44, v45
    v_mfma_f32_16x16x32_bf16 v[192:195], a[164:167], v[112:115], v[192:195]
    buffer_store_dwordx4 a[232:235], v4, s[72:75], s76 offen offset:2176 nt
    v_mfma_f32_16x16x32_bf16 v[196:199], a[164:167], v[116:119], v[196:199]
    ds_read_b64_tr_b16 a[178:179], v2 offset:54016
    v_mfma_f32_16x16x32_bf16 v[196:199], a[160:163], v[100:103], v[196:199]
    v_exp_f32 v46, v46
    v_mfma_f32_16x16x32_bf16 v[200:203], a[160:163], v[104:107], v[200:203]
    ds_read_b128 a[152:155], v1 offset:12800
    v_mfma_f32_16x16x32_bf16 v[200:203], a[164:167], v[120:123], v[200:203]
    ds_read_b64_tr_b16 a[180:181], v2 offset:58112
    v_mfma_f32_16x16x32_bf16 v[204:207], a[164:167], v[124:127], v[204:207]
    v_exp_f32 v47, v47
    v_mfma_f32_16x16x32_bf16 v[204:207], a[160:163], v[108:111], v[204:207]
    buffer_load_dwordx4 v5, s[12:15], s41 offen offset:3072 nt lds
    v_mfma_f32_16x16x32_bf16 v[208:211], a[168:171], v[96:99], v[208:211]
    ds_read_b128 a[156:159], v1 offset:13056
    v_cvt_pk_bf16_f32 v85, v46, v47
    v_mfma_f32_16x16x32_bf16 v[208:211], a[172:175], v[112:115], v[208:211]
    ds_read_b64_tr_b16 a[182:183], v2 offset:62208
    v_mfma_f32_16x16x32_bf16 v[212:215], a[172:175], v[116:119], v[212:215]
    v_exp_f32 v62, v62
    v_mfma_f32_16x16x32_bf16 v[212:215], a[168:171], v[100:103], v[212:215]
    v_exp_f32 v63, v63
    v_mfma_f32_16x16x32_bf16 v[216:219], a[168:171], v[104:107], v[216:219]
    ds_read_b64_tr_b16 a[184:185], v2 offset:49928
    v_cvt_pk_bf16_f32 v79, v62, v63
    v_mfma_f32_16x16x32_bf16 v[216:219], a[172:175], v[120:123], v[216:219]
    s_add_u32 m0, s66, 0
    v_exp_f32 v48, v48
    v_mfma_f32_16x16x32_bf16 v[220:223], a[172:175], v[124:127], v[220:223]
    v_exp_f32 v49, v49
    v_mfma_f32_16x16x32_bf16 v[220:223], a[168:171], v[108:111], v[220:223]
    v_exp_f32 v50, v50
    v_mfma_f32_16x16x32_bf16 a[200:203], a[208:211], v[104:107], a[200:203]
    s_waitcnt lgkmcnt(2)
    ds_read_b64_tr_b16 a[186:187], v2 offset:54024
    v_cvt_pk_bf16_f32 v88, v48, v49
    v_mfma_f32_16x16x32_bf16 a[200:203], a[208:211], v[120:123], a[200:203]
    v_exp_f32 v51, v51
    v_mfma_f32_16x16x32_bf16 v[40:43], a[144:147], a[0:3], v[20:23]
    v_exp_f32 v56, v56
    v_mfma_f32_16x16x32_bf16 v[40:43], a[148:151], a[4:7], v[40:43]
    v_exp_f32 v57, v57
    v_mfma_f32_16x16x32_bf16 v[40:43], a[152:155], a[8:11], v[40:43]
    ds_read_b64_tr_b16 a[188:189], v2 offset:58120
    v_cvt_pk_bf16_f32 v89, v50, v51
    v_mfma_f32_16x16x32_bf16 v[40:43], a[156:159], a[12:15], v[40:43]
    buffer_load_dwordx4 v6, s[68:71], s64 offen offset:1024 nt lds
    v_mfma_f32_16x16x32_bf16 v[44:47], a[156:159], a[28:31], v[24:27]
    v_exp_f32 v58, v58
    v_mfma_f32_16x16x32_bf16 v[44:47], a[152:155], a[24:27], v[44:47]
    v_exp_f32 v59, v59
    v_mfma_f32_16x16x32_bf16 v[44:47], a[148:151], a[20:23], v[44:47]
    ds_read_b64_tr_b16 a[190:191], v2 offset:62216
    v_cvt_pk_bf16_f32 v92, v56, v57
    v_mfma_f32_16x16x32_bf16 v[44:47], a[144:147], a[16:19], v[44:47]
    v_exp_f32 v40, v40
    v_mfma_f32_16x16x32_bf16 v[52:55], a[144:147], a[32:35], v[28:31]
    v_exp_f32 v41, v41
    v_mfma_f32_16x16x32_bf16 v[52:55], a[148:151], a[36:39], v[52:55]
    v_exp_f32 v42, v42
    v_mfma_f32_16x16x32_bf16 v[52:55], a[152:155], a[40:43], v[52:55]
    v_exp_f32 v43, v43
    v_mfma_f32_16x16x32_bf16 v[52:55], a[156:159], a[44:47], v[52:55]
    v_cvt_pk_bf16_f32 v82, v40, v41
    v_cvt_pk_bf16_f32 v83, v42, v43
    v_mfma_f32_16x16x32_bf16 v[60:63], a[156:159], a[60:63], v[32:35]
    v_exp_f32 v44, v44
    v_mfma_f32_16x16x32_bf16 v[60:63], a[152:155], a[56:59], v[60:63]
    s_waitcnt lgkmcnt(0)
    v_exp_f32 v45, v45
    v_mfma_f32_16x16x32_bf16 v[60:63], a[148:151], a[52:55], v[60:63]
    s_waitcnt vmcnt(24)
    v_exp_f32 v46, v46
    v_mfma_f32_16x16x32_bf16 v[60:63], a[144:147], a[48:51], v[60:63]
    s_barrier
    v_mfma_f32_16x16x32_bf16 v[224:227], a[176:179], v[96:99], v[224:227]
    s_add_u32 s40, s29, 0
    ds_read_b128 a[128:131], v1 offset:16384
    v_cvt_pk_bf16_f32 v86, v44, v45
    v_mfma_f32_16x16x32_bf16 v[224:227], a[180:183], v[112:115], v[224:227]
    s_add_u32 s41, s28, 114688
    ds_read_b64_tr_b16 a[160:161], v2 offset:0
    v_cvt_pk_bf16_f32 v93, v58, v59
    v_mfma_f32_16x16x32_bf16 v[228:231], a[180:183], v[116:119], v[228:231]
    s_add_u32 m0, s39, 0
    ds_read_b128 a[132:135], v1 offset:16640
    v_mfma_f32_16x16x32_bf16 v[228:231], a[176:179], v[100:103], v[228:231]
    ds_read_b64_tr_b16 a[162:163], v2 offset:4096
    v_mfma_f32_16x16x32_bf16 v[232:235], a[176:179], v[104:107], v[232:235]
    ds_read_b128 a[136:139], v1 offset:16896
    v_mfma_f32_16x16x32_bf16 v[232:235], a[180:183], v[120:123], v[232:235]
    buffer_load_dwordx4 v5, s[20:23], s40 offen offset:0 nt lds
    v_mfma_f32_16x16x32_bf16 v[236:239], a[180:183], v[124:127], v[236:239]
    ds_read_b64_tr_b16 a[164:165], v2 offset:8192
    v_mfma_f32_16x16x32_bf16 v[236:239], a[176:179], v[108:111], v[236:239]
    v_exp_f32 v47, v47
    v_mfma_f32_16x16x32_bf16 v[240:243], a[184:187], v[96:99], v[240:243]
    ds_read_b128 a[140:143], v1 offset:17152
    v_cvt_pk_bf16_f32 v87, v46, v47
    v_mfma_f32_16x16x32_bf16 v[240:243], a[188:191], v[112:115], v[240:243]
    ds_read_b64_tr_b16 a[166:167], v2 offset:12288
    v_mfma_f32_16x16x32_bf16 v[244:247], a[188:191], v[116:119], v[244:247]
    v_exp_f32 v52, v52
    v_mfma_f32_16x16x32_bf16 v[244:247], a[184:187], v[100:103], v[244:247]
    v_exp_f32 v53, v53
    v_mfma_f32_16x16x32_bf16 v[248:251], a[184:187], v[104:107], v[248:251]
    ds_read_b64_tr_b16 a[168:169], v2 offset:8
    v_cvt_pk_bf16_f32 v90, v52, v53
    v_mfma_f32_16x16x32_bf16 v[248:251], a[188:191], v[120:123], v[248:251]
    v_exp_f32 v54, v54
    v_mfma_f32_16x16x32_bf16 v[252:255], a[188:191], v[124:127], v[252:255]
    v_exp_f32 v55, v55
    v_mfma_f32_16x16x32_bf16 v[252:255], a[184:187], v[108:111], v[252:255]
    v_exp_f32 v60, v60
    v_mfma_f32_16x16x32_bf16 a[204:207], a[208:211], v[108:111], a[204:207]
    s_waitcnt lgkmcnt(2)
    ds_read_b64_tr_b16 a[170:171], v2 offset:4104
    v_cvt_pk_bf16_f32 v91, v54, v55
    v_mfma_f32_16x16x32_bf16 a[204:207], a[208:211], v[124:127], a[204:207]
    buffer_load_dwordx4 v6, s[20:23], s40 offen offset:1024 nt lds
    v_mfma_f32_16x16x32_bf16 v[40:43], a[128:131], a[0:3], v[20:23]
    v_exp_f32 v61, v61
    v_mfma_f32_16x16x32_bf16 v[40:43], a[132:135], a[4:7], v[40:43]
    v_exp_f32 v62, v62
    v_mfma_f32_16x16x32_bf16 v[40:43], a[136:139], a[8:11], v[40:43]
    ds_read_b64_tr_b16 a[172:173], v2 offset:8200
    v_cvt_pk_bf16_f32 v94, v60, v61
    v_mfma_f32_16x16x32_bf16 v[40:43], a[140:143], a[12:15], v[40:43]
    v_exp_f32 v63, v63
    v_mfma_f32_16x16x32_bf16 v[44:47], a[140:143], a[28:31], v[24:27]
    v_cvt_pk_bf16_f32 v95, v62, v63
    v_mfma_f32_16x16x32_bf16 v[44:47], a[136:139], a[24:27], v[44:47]
    s_add_u32 m0, s66, 0
    v_mfma_f32_16x16x32_bf16 v[44:47], a[132:135], a[20:23], v[44:47]
    ds_read_b64_tr_b16 a[174:175], v2 offset:12296
    v_mfma_f32_16x16x32_bf16 v[44:47], a[128:131], a[16:19], v[44:47]
    v_exp_f32 v40, v40
    v_mfma_f32_16x16x32_bf16 v[48:51], a[128:131], a[32:35], v[28:31]
    v_exp_f32 v41, v41
    v_mfma_f32_16x16x32_bf16 v[48:51], a[132:135], a[36:39], v[48:51]
    v_exp_f32 v42, v42
    v_mfma_f32_16x16x32_bf16 v[48:51], a[136:139], a[40:43], v[48:51]
    v_exp_f32 v43, v43
    v_mfma_f32_16x16x32_bf16 v[48:51], a[140:143], a[44:47], v[48:51]
    buffer_load_dwordx4 v7, s[68:71], s64 offen offset:2048 nt lds
    v_mfma_f32_16x16x32_bf16 v[56:59], a[140:143], a[60:63], v[32:35]
    ds_read_b128 a[144:147], v1 offset:20480
    v_cvt_pk_bf16_f32 v96, v40, v41
    v_mfma_f32_16x16x32_bf16 v[56:59], a[136:139], a[56:59], v[56:59]
    ds_read_b64_tr_b16 a[176:177], v2 offset:256
    v_cvt_pk_bf16_f32 v97, v42, v43
    v_mfma_f32_16x16x32_bf16 v[56:59], a[132:135], a[52:55], v[56:59]
    s_waitcnt lgkmcnt(2)
    v_exp_f32 v44, v44
    v_mfma_f32_16x16x32_bf16 v[56:59], a[128:131], a[48:51], v[56:59]
    v_exp_f32 v45, v45
    v_mfma_f32_16x16x32_bf16 v[128:131], a[160:163], v[64:67], v[128:131]
    s_add_u32 m0, s39, 0
    ds_read_b128 a[148:151], v1 offset:20736
    v_cvt_pk_bf16_f32 v100, v44, v45
    v_mfma_f32_16x16x32_bf16 v[128:131], a[164:167], v[80:83], v[128:131]
    ds_read_b64_tr_b16 a[178:179], v2 offset:4352
    v_mfma_f32_16x16x32_bf16 v[132:135], a[164:167], v[84:87], v[132:135]
    v_exp_f32 v46, v46
    v_mfma_f32_16x16x32_bf16 v[132:135], a[160:163], v[68:71], v[132:135]
    v_exp_f32 v47, v47
    v_mfma_f32_16x16x32_bf16 v[136:139], a[160:163], v[72:75], v[136:139]
    ds_read_b128 a[152:155], v1 offset:20992
    v_cvt_pk_bf16_f32 v101, v46, v47
    v_mfma_f32_16x16x32_bf16 v[136:139], a[164:167], v[88:91], v[136:139]
    ds_read_b64_tr_b16 a[180:181], v2 offset:8448
    v_mfma_f32_16x16x32_bf16 v[140:143], a[164:167], v[92:95], v[140:143]
    v_exp_f32 v48, v48
    v_mfma_f32_16x16x32_bf16 v[140:143], a[160:163], v[76:79], v[140:143]
    buffer_load_dwordx4 v7, s[20:23], s40 offen offset:2048 nt lds
    v_mfma_f32_16x16x32_bf16 v[144:147], a[168:171], v[64:67], v[144:147]
    ds_read_b128 a[156:159], v1 offset:21248
    v_mfma_f32_16x16x32_bf16 v[144:147], a[172:175], v[80:83], v[144:147]
    ds_read_b64_tr_b16 a[182:183], v2 offset:12544
    v_mfma_f32_16x16x32_bf16 v[148:151], a[172:175], v[84:87], v[148:151]
    v_exp_f32 v49, v49
    v_mfma_f32_16x16x32_bf16 v[148:151], a[168:171], v[68:71], v[148:151]
    v_exp_f32 v50, v50
    v_mfma_f32_16x16x32_bf16 v[152:155], a[168:171], v[72:75], v[152:155]
    ds_read_b64_tr_b16 a[184:185], v2 offset:264
    v_cvt_pk_bf16_f32 v104, v48, v49
    v_mfma_f32_16x16x32_bf16 v[152:155], a[172:175], v[88:91], v[152:155]
    v_exp_f32 v51, v51
    v_mfma_f32_16x16x32_bf16 v[156:159], a[172:175], v[92:95], v[156:159]
    s_waitcnt vmcnt(22)
    v_exp_f32 v56, v56
    v_mfma_f32_16x16x32_bf16 v[156:159], a[168:171], v[76:79], v[156:159]
    v_exp_f32 v57, v57
    v_mfma_f32_16x16x32_bf16 a[192:195], a[208:211], v[64:67], a[192:195]
    s_waitcnt lgkmcnt(2)
    ds_read_b64_tr_b16 a[186:187], v2 offset:4360
    v_cvt_pk_bf16_f32 v105, v50, v51
    v_mfma_f32_16x16x32_bf16 a[192:195], a[208:211], v[80:83], a[192:195]
    v_exp_f32 v58, v58
    v_mfma_f32_16x16x32_bf16 v[40:43], a[144:147], a[0:3], v[20:23]
    v_exp_f32 v59, v59
    v_mfma_f32_16x16x32_bf16 v[40:43], a[148:151], a[4:7], v[40:43]
    v_cvt_pk_bf16_f32 v108, v56, v57
    v_cvt_pk_bf16_f32 v109, v58, v59
    v_mfma_f32_16x16x32_bf16 v[40:43], a[152:155], a[8:11], v[40:43]
    ds_read_b64_tr_b16 a[188:189], v2 offset:8456
    v_mfma_f32_16x16x32_bf16 v[40:43], a[156:159], a[12:15], v[40:43]
    buffer_load_dwordx4 v8, s[20:23], s40 offen offset:3072 nt lds
    v_mfma_f32_16x16x32_bf16 v[44:47], a[156:159], a[28:31], v[24:27]
    v_mfma_f32_16x16x32_bf16 v[44:47], a[152:155], a[24:27], v[44:47]
    v_mfma_f32_16x16x32_bf16 v[44:47], a[148:151], a[20:23], v[44:47]
    s_add_u32 m0, s66, 0
    ds_read_b64_tr_b16 a[190:191], v2 offset:12552
    v_mfma_f32_16x16x32_bf16 v[44:47], a[144:147], a[16:19], v[44:47]
    v_mfma_f32_16x16x32_bf16 v[52:55], a[144:147], a[32:35], v[28:31]
    ds_read_b128 a[80:83], v9 offset:4096
    v_mfma_f32_16x16x32_bf16 v[52:55], a[148:151], a[36:39], v[52:55]
    v_exp_f32 v40, v40
    v_mfma_f32_16x16x32_bf16 v[52:55], a[152:155], a[40:43], v[52:55]
    v_exp_f32 v41, v41
    v_mfma_f32_16x16x32_bf16 v[52:55], a[156:159], a[44:47], v[52:55]
    v_exp_f32 v42, v42
    v_mfma_f32_16x16x32_bf16 v[60:63], a[156:159], a[60:63], v[32:35]
    ds_read_b128 a[84:87], v9 offset:4352
    v_cvt_pk_bf16_f32 v98, v40, v41
    v_mfma_f32_16x16x32_bf16 v[60:63], a[152:155], a[56:59], v[60:63]
    ds_read_b128 a[128:131], v1 offset:24576
    v_mfma_f32_16x16x32_bf16 v[60:63], a[148:151], a[52:55], v[60:63]
    s_waitcnt lgkmcnt(3)
    ds_read_b64_tr_b16 a[160:161], v2 offset:512
    v_mfma_f32_16x16x32_bf16 v[60:63], a[144:147], a[48:51], v[60:63]
    buffer_load_dwordx4 v8, s[68:71], s64 offen offset:3072 nt lds
    v_mfma_f32_16x16x32_bf16 v[160:163], a[176:179], v[64:67], v[160:163]
    ds_read_b128 a[88:91], v9 offset:4608
    v_mfma_f32_16x16x32_bf16 v[160:163], a[180:183], v[80:83], v[160:163]
    s_add_u32 m0, s39, 114688
    ds_read_b128 a[132:135], v1 offset:24832
    v_mfma_f32_16x16x32_bf16 v[164:167], a[180:183], v[84:87], v[164:167]
    ds_read_b64_tr_b16 a[162:163], v2 offset:4608
    v_mfma_f32_16x16x32_bf16 v[164:167], a[176:179], v[68:71], v[164:167]
    buffer_store_dwordx4 a[120:123], v4, s[72:75], s77 offen offset:0 nt
    v_mfma_f32_16x16x32_bf16 v[168:171], a[176:179], v[72:75], v[168:171]
    ds_read_b128 a[92:95], v9 offset:4864
    v_mfma_f32_16x16x32_bf16 v[168:171], a[180:183], v[88:91], v[168:171]
    ds_read_b128 a[136:139], v1 offset:25088
    v_mfma_f32_16x16x32_bf16 v[172:175], a[180:183], v[92:95], v[172:175]
    ds_read_b64_tr_b16 a[164:165], v2 offset:8704
    v_mfma_f32_16x16x32_bf16 v[172:175], a[176:179], v[76:79], v[172:175]
    buffer_load_dwordx4 v5, s[12:15], s41 offen offset:0 nt lds
    v_mfma_f32_16x16x32_bf16 v[176:179], a[184:187], v[64:67], v[176:179]
    ds_read_b128 a[140:143], v1 offset:25344
    v_mfma_f32_16x16x32_bf16 v[176:179], a[188:191], v[80:83], v[176:179]
    ds_read_b64_tr_b16 a[166:167], v2 offset:12800
    v_mfma_f32_16x16x32_bf16 v[180:183], a[188:191], v[84:87], v[180:183]
    v_exp_f32 v43, v43
    v_mfma_f32_16x16x32_bf16 v[180:183], a[184:187], v[68:71], v[180:183]
    v_exp_f32 v44, v44
    v_mfma_f32_16x16x32_bf16 v[184:187], a[184:187], v[72:75], v[184:187]
    ds_read_b64_tr_b16 a[168:169], v2 offset:520
    v_cvt_pk_bf16_f32 v99, v42, v43
    v_mfma_f32_16x16x32_bf16 v[184:187], a[188:191], v[88:91], v[184:187]
    v_exp_f32 v45, v45
    v_mfma_f32_16x16x32_bf16 v[188:191], a[188:191], v[92:95], v[188:191]
    v_exp_f32 v46, v46
    v_mfma_f32_16x16x32_bf16 v[188:191], a[184:187], v[76:79], v[188:191]
    v_exp_f32 v47, v47
    v_mfma_f32_16x16x32_bf16 a[196:199], a[208:211], v[68:71], a[196:199]
    s_waitcnt lgkmcnt(2)
    ds_read_b64_tr_b16 a[170:171], v2 offset:4616
    v_cvt_pk_bf16_f32 v102, v44, v45
    v_mfma_f32_16x16x32_bf16 a[196:199], a[208:211], v[84:87], a[196:199]
    v_exp_f32 v52, v52
    v_mfma_f32_16x16x32_bf16 v[40:43], a[128:131], a[0:3], v[20:23]
    v_exp_f32 v53, v53
    v_mfma_f32_16x16x32_bf16 v[40:43], a[132:135], a[4:7], v[40:43]
    v_cvt_pk_bf16_f32 v103, v46, v47
    v_cvt_pk_bf16_f32 v106, v52, v53
    v_mfma_f32_16x16x32_bf16 v[40:43], a[136:139], a[8:11], v[40:43]
    ds_read_b64_tr_b16 a[172:173], v2 offset:8712
    v_mfma_f32_16x16x32_bf16 v[40:43], a[140:143], a[12:15], v[40:43]
    buffer_load_dwordx4 v5, s[12:15], s41 offen offset:1024 nt lds
    v_mfma_f32_16x16x32_bf16 v[44:47], a[140:143], a[28:31], v[24:27]
    v_exp_f32 v54, v54
    v_mfma_f32_16x16x32_bf16 v[44:47], a[136:139], a[24:27], v[44:47]
    v_exp_f32 v55, v55
    v_mfma_f32_16x16x32_bf16 v[44:47], a[132:135], a[20:23], v[44:47]
    ds_read_b64_tr_b16 a[174:175], v2 offset:12808
    v_cvt_pk_bf16_f32 v107, v54, v55
    v_mfma_f32_16x16x32_bf16 v[44:47], a[128:131], a[16:19], v[44:47]
    v_exp_f32 v40, v40
    v_mfma_f32_16x16x32_bf16 v[48:51], a[128:131], a[32:35], v[28:31]
    v_exp_f32 v41, v41
    v_mfma_f32_16x16x32_bf16 v[48:51], a[132:135], a[36:39], v[48:51]
    v_exp_f32 v42, v42
    v_mfma_f32_16x16x32_bf16 v[48:51], a[136:139], a[40:43], v[48:51]
    v_exp_f32 v43, v43
    v_mfma_f32_16x16x32_bf16 v[48:51], a[140:143], a[44:47], v[48:51]
    v_cvt_pk_bf16_f32 v112, v40, v41
    v_cvt_pk_bf16_f32 v113, v42, v43
    v_mfma_f32_16x16x32_bf16 v[56:59], a[140:143], a[60:63], v[32:35]
    ds_read_b128 a[144:147], v1 offset:28672
    v_mfma_f32_16x16x32_bf16 v[56:59], a[136:139], a[56:59], v[56:59]
    ds_read_b64_tr_b16 a[176:177], v2 offset:768
    v_mfma_f32_16x16x32_bf16 v[56:59], a[132:135], a[52:55], v[56:59]
    s_waitcnt lgkmcnt(2)
    v_exp_f32 v44, v44
    v_mfma_f32_16x16x32_bf16 v[56:59], a[128:131], a[48:51], v[56:59]
    buffer_load_dwordx4 v5, s[12:15], s41 offen offset:2048 nt lds
    v_mfma_f32_16x16x32_bf16 v[192:195], a[160:163], v[64:67], v[192:195]
    ds_read_b128 a[148:151], v1 offset:28928
    v_mfma_f32_16x16x32_bf16 v[192:195], a[164:167], v[80:83], v[192:195]
    ds_read_b64_tr_b16 a[178:179], v2 offset:4864
    v_mfma_f32_16x16x32_bf16 v[196:199], a[164:167], v[84:87], v[196:199]
    v_exp_f32 v45, v45
    v_mfma_f32_16x16x32_bf16 v[196:199], a[160:163], v[68:71], v[196:199]
    v_exp_f32 v46, v46
    v_mfma_f32_16x16x32_bf16 v[200:203], a[160:163], v[72:75], v[200:203]
    ds_read_b128 a[152:155], v1 offset:29184
    v_cvt_pk_bf16_f32 v116, v44, v45
    v_mfma_f32_16x16x32_bf16 v[200:203], a[164:167], v[88:91], v[200:203]
    ds_read_b64_tr_b16 a[180:181], v2 offset:8960
    v_mfma_f32_16x16x32_bf16 v[204:207], a[164:167], v[92:95], v[204:207]
    v_exp_f32 v47, v47
    v_mfma_f32_16x16x32_bf16 v[204:207], a[160:163], v[76:79], v[204:207]
    v_exp_f32 v60, v60
    v_mfma_f32_16x16x32_bf16 v[208:211], a[168:171], v[64:67], v[208:211]
    ds_read_b128 a[156:159], v1 offset:29440
    v_cvt_pk_bf16_f32 v117, v46, v47
    v_mfma_f32_16x16x32_bf16 v[208:211], a[172:175], v[80:83], v[208:211]
    buffer_load_dwordx4 v5, s[12:15], s41 offen offset:3072 nt lds
    v_mfma_f32_16x16x32_bf16 v[212:215], a[172:175], v[84:87], v[212:215]
    ds_read_b64_tr_b16 a[182:183], v2 offset:13056
    v_mfma_f32_16x16x32_bf16 v[212:215], a[168:171], v[68:71], v[212:215]
    v_exp_f32 v61, v61
    v_mfma_f32_16x16x32_bf16 v[216:219], a[168:171], v[72:75], v[216:219]
    ds_read_b64_tr_b16 a[184:185], v2 offset:776
    v_cvt_pk_bf16_f32 v110, v60, v61
    v_mfma_f32_16x16x32_bf16 v[216:219], a[172:175], v[88:91], v[216:219]
    v_exp_f32 v62, v62
    v_mfma_f32_16x16x32_bf16 v[220:223], a[172:175], v[92:95], v[220:223]
    s_add_u32 m0, s66, 4096
    v_exp_f32 v63, v63
    v_mfma_f32_16x16x32_bf16 v[220:223], a[168:171], v[76:79], v[220:223]
    v_exp_f32 v48, v48
    v_mfma_f32_16x16x32_bf16 a[200:203], a[208:211], v[72:75], a[200:203]
    s_waitcnt lgkmcnt(2)
    ds_read_b64_tr_b16 a[186:187], v2 offset:4872
    v_cvt_pk_bf16_f32 v111, v62, v63
    v_mfma_f32_16x16x32_bf16 a[200:203], a[208:211], v[88:91], a[200:203]
    v_exp_f32 v49, v49
    v_mfma_f32_16x16x32_bf16 v[40:43], a[144:147], a[0:3], v[20:23]
    v_exp_f32 v50, v50
    v_mfma_f32_16x16x32_bf16 v[40:43], a[148:151], a[4:7], v[40:43]
    v_exp_f32 v51, v51
    v_mfma_f32_16x16x32_bf16 v[40:43], a[152:155], a[8:11], v[40:43]
    s_waitcnt lgkmcnt(15)
    ds_read_b64_tr_b16 a[188:189], v2 offset:8968
    v_cvt_pk_bf16_f32 v120, v48, v49
    v_mfma_f32_16x16x32_bf16 v[40:43], a[156:159], a[12:15], v[40:43]
    buffer_load_dwordx4 v5, s[68:71], s65 offen offset:0 nt lds
    v_mfma_f32_16x16x32_bf16 v[44:47], a[156:159], a[28:31], v[24:27]
    v_exp_f32 v56, v56
    v_mfma_f32_16x16x32_bf16 v[44:47], a[152:155], a[24:27], v[44:47]
    v_exp_f32 v57, v57
    v_mfma_f32_16x16x32_bf16 v[44:47], a[148:151], a[20:23], v[44:47]
    ds_read_b64_tr_b16 a[190:191], v2 offset:13064
    v_cvt_pk_bf16_f32 v121, v50, v51
    v_mfma_f32_16x16x32_bf16 v[44:47], a[144:147], a[16:19], v[44:47]
    v_exp_f32 v40, v40
    v_mfma_f32_16x16x32_bf16 v[52:55], a[144:147], a[32:35], v[28:31]
    v_exp_f32 v41, v41
    v_mfma_f32_16x16x32_bf16 v[52:55], a[148:151], a[36:39], v[52:55]
    v_exp_f32 v42, v42
    v_mfma_f32_16x16x32_bf16 v[52:55], a[152:155], a[40:43], v[52:55]
    v_exp_f32 v43, v43
    v_mfma_f32_16x16x32_bf16 v[52:55], a[156:159], a[44:47], v[52:55]
    v_cvt_pk_bf16_f32 v114, v40, v41
    v_cvt_pk_bf16_f32 v115, v42, v43
    v_mfma_f32_16x16x32_bf16 v[60:63], a[156:159], a[60:63], v[32:35]
    v_exp_f32 v44, v44
    v_mfma_f32_16x16x32_bf16 v[60:63], a[152:155], a[56:59], v[60:63]
    s_waitcnt lgkmcnt(0)
    v_exp_f32 v45, v45
    v_mfma_f32_16x16x32_bf16 v[60:63], a[148:151], a[52:55], v[60:63]
    s_waitcnt vmcnt(24)
    v_exp_f32 v46, v46
    v_mfma_f32_16x16x32_bf16 v[60:63], a[144:147], a[48:51], v[60:63]
    s_barrier
    v_mfma_f32_16x16x32_bf16 v[224:227], a[176:179], v[64:67], v[224:227]
    s_add_u32 s40, s29, 16384
    ds_read_b128 a[128:131], v1 offset:32768
    v_cvt_pk_bf16_f32 v118, v44, v45
    v_mfma_f32_16x16x32_bf16 v[224:227], a[180:183], v[80:83], v[224:227]
    s_add_u32 s41, s29, 0
    ds_read_b64_tr_b16 a[160:161], v2 offset:16384
    v_cvt_pk_bf16_f32 v124, v56, v57
    v_mfma_f32_16x16x32_bf16 v[228:231], a[180:183], v[84:87], v[228:231]
    s_add_u32 m0, s39, 16384
    ds_read_b128 a[132:135], v1 offset:33024
    v_mfma_f32_16x16x32_bf16 v[228:231], a[176:179], v[68:71], v[228:231]
    ds_read_b64_tr_b16 a[162:163], v2 offset:20480
    v_mfma_f32_16x16x32_bf16 v[232:235], a[176:179], v[72:75], v[232:235]
    ds_read_b128 a[136:139], v1 offset:33280
    v_mfma_f32_16x16x32_bf16 v[232:235], a[180:183], v[88:91], v[232:235]
    buffer_load_dwordx4 v5, s[20:23], s40 offen offset:0 nt lds
    v_mfma_f32_16x16x32_bf16 v[236:239], a[180:183], v[92:95], v[236:239]
    ds_read_b64_tr_b16 a[164:165], v2 offset:24576
    v_mfma_f32_16x16x32_bf16 v[236:239], a[176:179], v[76:79], v[236:239]
    v_exp_f32 v47, v47
    v_mfma_f32_16x16x32_bf16 v[240:243], a[184:187], v[64:67], v[240:243]
    ds_read_b128 a[140:143], v1 offset:33536
    v_cvt_pk_bf16_f32 v119, v46, v47
    v_mfma_f32_16x16x32_bf16 v[240:243], a[188:191], v[80:83], v[240:243]
    ds_read_b64_tr_b16 a[166:167], v2 offset:28672
    v_mfma_f32_16x16x32_bf16 v[244:247], a[188:191], v[84:87], v[244:247]
    v_exp_f32 v58, v58
    v_mfma_f32_16x16x32_bf16 v[244:247], a[184:187], v[68:71], v[244:247]
    v_exp_f32 v59, v59
    v_mfma_f32_16x16x32_bf16 v[248:251], a[184:187], v[72:75], v[248:251]
    ds_read_b64_tr_b16 a[168:169], v2 offset:16392
    v_cvt_pk_bf16_f32 v125, v58, v59
    v_mfma_f32_16x16x32_bf16 v[248:251], a[188:191], v[88:91], v[248:251]
    v_exp_f32 v52, v52
    v_mfma_f32_16x16x32_bf16 v[252:255], a[188:191], v[92:95], v[252:255]
    v_exp_f32 v53, v53
    v_mfma_f32_16x16x32_bf16 v[252:255], a[184:187], v[76:79], v[252:255]
    v_exp_f32 v54, v54
    v_mfma_f32_16x16x32_bf16 a[204:207], a[208:211], v[76:79], a[204:207]
    s_waitcnt lgkmcnt(2)
    ds_read_b64_tr_b16 a[170:171], v2 offset:20488
    v_cvt_pk_bf16_f32 v122, v52, v53
    v_mfma_f32_16x16x32_bf16 a[204:207], a[208:211], v[92:95], a[204:207]
    buffer_load_dwordx4 v6, s[20:23], s40 offen offset:1024 nt lds
    v_mfma_f32_16x16x32_bf16 v[40:43], a[128:131], a[0:3], v[20:23]
    v_exp_f32 v55, v55
    v_mfma_f32_16x16x32_bf16 v[40:43], a[132:135], a[4:7], v[40:43]
    v_exp_f32 v60, v60
    v_mfma_f32_16x16x32_bf16 v[40:43], a[136:139], a[8:11], v[40:43]
    ds_read_b64_tr_b16 a[172:173], v2 offset:24584
    v_cvt_pk_bf16_f32 v123, v54, v55
    v_mfma_f32_16x16x32_bf16 v[40:43], a[140:143], a[12:15], v[40:43]
    v_exp_f32 v61, v61
    v_mfma_f32_16x16x32_bf16 v[44:47], a[140:143], a[28:31], v[24:27]
    v_exp_f32 v62, v62
    v_mfma_f32_16x16x32_bf16 v[44:47], a[136:139], a[24:27], v[44:47]
    s_add_u32 m0, s66, 4096
    v_exp_f32 v63, v63
    v_mfma_f32_16x16x32_bf16 v[44:47], a[132:135], a[20:23], v[44:47]
    ds_read_b64_tr_b16 a[174:175], v2 offset:28680
    v_cvt_pk_bf16_f32 v126, v60, v61
    v_mfma_f32_16x16x32_bf16 v[44:47], a[128:131], a[16:19], v[44:47]
    v_exp_f32 v40, v40
    v_mfma_f32_16x16x32_bf16 v[48:51], a[128:131], a[32:35], v[28:31]
    v_exp_f32 v41, v41
    v_mfma_f32_16x16x32_bf16 v[48:51], a[132:135], a[36:39], v[48:51]
    v_cvt_pk_bf16_f32 v127, v62, v63
    v_cvt_pk_bf16_f32 v64, v40, v41
    v_mfma_f32_16x16x32_bf16 v[48:51], a[136:139], a[40:43], v[48:51]
    v_exp_f32 v42, v42
    v_mfma_f32_16x16x32_bf16 v[48:51], a[140:143], a[44:47], v[48:51]
    buffer_load_dwordx4 v6, s[68:71], s65 offen offset:1024 nt lds
    v_mfma_f32_16x16x32_bf16 v[56:59], a[140:143], a[60:63], v[32:35]
    ds_read_b128 a[144:147], v1 offset:36864
    v_mfma_f32_16x16x32_bf16 v[56:59], a[136:139], a[56:59], v[56:59]
    ds_read_b64_tr_b16 a[176:177], v2 offset:16640
    v_mfma_f32_16x16x32_bf16 v[56:59], a[132:135], a[52:55], v[56:59]
    s_waitcnt lgkmcnt(2)
    v_exp_f32 v43, v43
    v_mfma_f32_16x16x32_bf16 v[56:59], a[128:131], a[48:51], v[56:59]
    v_exp_f32 v44, v44
    v_mfma_f32_16x16x32_bf16 v[128:131], a[160:163], v[96:99], v[128:131]
    s_add_u32 m0, s39, 16384
    ds_read_b128 a[148:151], v1 offset:37120
    v_cvt_pk_bf16_f32 v65, v42, v43
    v_mfma_f32_16x16x32_bf16 v[128:131], a[164:167], v[112:115], v[128:131]
    ds_read_b64_tr_b16 a[178:179], v2 offset:20736
    v_mfma_f32_16x16x32_bf16 v[132:135], a[164:167], v[116:119], v[132:135]
    v_exp_f32 v45, v45
    v_mfma_f32_16x16x32_bf16 v[132:135], a[160:163], v[100:103], v[132:135]
    v_exp_f32 v46, v46
    v_mfma_f32_16x16x32_bf16 v[136:139], a[160:163], v[104:107], v[136:139]
    ds_read_b128 a[152:155], v1 offset:37376
    v_cvt_pk_bf16_f32 v68, v44, v45
    v_mfma_f32_16x16x32_bf16 v[136:139], a[164:167], v[120:123], v[136:139]
    ds_read_b64_tr_b16 a[180:181], v2 offset:24832
    v_mfma_f32_16x16x32_bf16 v[140:143], a[164:167], v[124:127], v[140:143]
    v_exp_f32 v47, v47
    v_mfma_f32_16x16x32_bf16 v[140:143], a[160:163], v[108:111], v[140:143]
    buffer_load_dwordx4 v7, s[20:23], s40 offen offset:2048 nt lds
    v_mfma_f32_16x16x32_bf16 v[144:147], a[168:171], v[96:99], v[144:147]
    ds_read_b128 a[156:159], v1 offset:37632
    v_cvt_pk_bf16_f32 v69, v46, v47
    v_mfma_f32_16x16x32_bf16 v[144:147], a[172:175], v[112:115], v[144:147]
    ds_read_b64_tr_b16 a[182:183], v2 offset:28928
    v_mfma_f32_16x16x32_bf16 v[148:151], a[172:175], v[116:119], v[148:151]
    v_exp_f32 v48, v48
    v_mfma_f32_16x16x32_bf16 v[148:151], a[168:171], v[100:103], v[148:151]
    v_exp_f32 v49, v49
    v_mfma_f32_16x16x32_bf16 v[152:155], a[168:171], v[104:107], v[152:155]
    ds_read_b64_tr_b16 a[184:185], v2 offset:16648
    v_cvt_pk_bf16_f32 v72, v48, v49
    v_mfma_f32_16x16x32_bf16 v[152:155], a[172:175], v[120:123], v[152:155]
    v_exp_f32 v50, v50
    v_mfma_f32_16x16x32_bf16 v[156:159], a[172:175], v[124:127], v[156:159]
    v_exp_f32 v51, v51
    v_mfma_f32_16x16x32_bf16 v[156:159], a[168:171], v[108:111], v[156:159]
    v_exp_f32 v56, v56
    v_mfma_f32_16x16x32_bf16 a[192:195], a[208:211], v[96:99], a[192:195]
    s_waitcnt lgkmcnt(2)
    ds_read_b64_tr_b16 a[186:187], v2 offset:20744
    v_cvt_pk_bf16_f32 v73, v50, v51
    v_mfma_f32_16x16x32_bf16 a[192:195], a[208:211], v[112:115], a[192:195]
    v_exp_f32 v57, v57
    v_mfma_f32_16x16x32_bf16 v[40:43], a[144:147], a[0:3], v[20:23]
    v_exp_f32 v58, v58
    v_mfma_f32_16x16x32_bf16 v[40:43], a[148:151], a[4:7], v[40:43]
    v_exp_f32 v59, v59
    v_mfma_f32_16x16x32_bf16 v[40:43], a[152:155], a[8:11], v[40:43]
    ds_read_b64_tr_b16 a[188:189], v2 offset:24840
    v_cvt_pk_bf16_f32 v76, v56, v57
    v_mfma_f32_16x16x32_bf16 v[40:43], a[156:159], a[12:15], v[40:43]
    buffer_load_dwordx4 v8, s[20:23], s40 offen offset:3072 nt lds
    v_mfma_f32_16x16x32_bf16 v[44:47], a[156:159], a[28:31], v[24:27]
    v_cvt_pk_bf16_f32 v77, v58, v59
    v_mfma_f32_16x16x32_bf16 v[44:47], a[152:155], a[24:27], v[44:47]
    v_mfma_f32_16x16x32_bf16 v[44:47], a[148:151], a[20:23], v[44:47]
    s_add_u32 m0, s66, 4096
    ds_read_b64_tr_b16 a[190:191], v2 offset:28936
    v_mfma_f32_16x16x32_bf16 v[44:47], a[144:147], a[16:19], v[44:47]
    v_exp_f32 v40, v40
    v_mfma_f32_16x16x32_bf16 v[52:55], a[144:147], a[32:35], v[28:31]
    v_exp_f32 v41, v41
    v_mfma_f32_16x16x32_bf16 v[52:55], a[148:151], a[36:39], v[52:55]
    v_exp_f32 v42, v42
    v_mfma_f32_16x16x32_bf16 v[52:55], a[152:155], a[40:43], v[52:55]
    v_exp_f32 v43, v43
    v_mfma_f32_16x16x32_bf16 v[52:55], a[156:159], a[44:47], v[52:55]
    v_cvt_pk_bf16_f32 v66, v40, v41
    v_cvt_pk_bf16_f32 v67, v42, v43
    v_mfma_f32_16x16x32_bf16 v[60:63], a[156:159], a[60:63], v[32:35]
    ds_read_b128 a[128:131], v1 offset:40960
    v_mfma_f32_16x16x32_bf16 v[60:63], a[152:155], a[56:59], v[60:63]
    ds_read_b64_tr_b16 a[160:161], v2 offset:16896
    v_mfma_f32_16x16x32_bf16 v[60:63], a[148:151], a[52:55], v[60:63]
    s_waitcnt lgkmcnt(2)
    v_exp_f32 v44, v44
    v_mfma_f32_16x16x32_bf16 v[60:63], a[144:147], a[48:51], v[60:63]
    buffer_load_dwordx4 v7, s[68:71], s65 offen offset:2048 nt lds
    v_mfma_f32_16x16x32_bf16 v[160:163], a[176:179], v[96:99], v[160:163]
    ds_read_b128 a[132:135], v1 offset:41216
    v_mfma_f32_16x16x32_bf16 v[160:163], a[180:183], v[112:115], v[160:163]
    s_add_u32 m0, s39, 65536
    ds_read_b64_tr_b16 a[162:163], v2 offset:20992
    v_mfma_f32_16x16x32_bf16 v[164:167], a[180:183], v[116:119], v[164:167]
    v_exp_f32 v45, v45
    v_mfma_f32_16x16x32_bf16 v[164:167], a[176:179], v[100:103], v[164:167]
    v_exp_f32 v46, v46
    v_mfma_f32_16x16x32_bf16 v[168:171], a[176:179], v[104:107], v[168:171]
    ds_read_b128 a[136:139], v1 offset:41472
    v_cvt_pk_bf16_f32 v70, v44, v45
    v_mfma_f32_16x16x32_bf16 v[168:171], a[180:183], v[120:123], v[168:171]
    ds_read_b64_tr_b16 a[164:165], v2 offset:25088
    v_mfma_f32_16x16x32_bf16 v[172:175], a[180:183], v[124:127], v[172:175]
    v_exp_f32 v47, v47
    v_mfma_f32_16x16x32_bf16 v[172:175], a[176:179], v[108:111], v[172:175]
    buffer_load_dwordx4 v5, s[24:27], s41 offen offset:0 nt lds
    v_mfma_f32_16x16x32_bf16 v[176:179], a[184:187], v[96:99], v[176:179]
    ds_read_b128 a[140:143], v1 offset:41728
    v_cvt_pk_bf16_f32 v71, v46, v47
    v_mfma_f32_16x16x32_bf16 v[176:179], a[188:191], v[112:115], v[176:179]
    ds_read_b64_tr_b16 a[166:167], v2 offset:29184
    v_mfma_f32_16x16x32_bf16 v[180:183], a[188:191], v[116:119], v[180:183]
    v_exp_f32 v52, v52
    v_mfma_f32_16x16x32_bf16 v[180:183], a[184:187], v[100:103], v[180:183]
    v_exp_f32 v53, v53
    v_mfma_f32_16x16x32_bf16 v[184:187], a[184:187], v[104:107], v[184:187]
    ds_read_b64_tr_b16 a[168:169], v2 offset:16904
    v_cvt_pk_bf16_f32 v74, v52, v53
    v_mfma_f32_16x16x32_bf16 v[184:187], a[188:191], v[120:123], v[184:187]
    v_exp_f32 v54, v54
    v_mfma_f32_16x16x32_bf16 v[188:191], a[188:191], v[124:127], v[188:191]
    v_exp_f32 v55, v55
    v_mfma_f32_16x16x32_bf16 v[188:191], a[184:187], v[108:111], v[188:191]
    v_exp_f32 v60, v60
    v_mfma_f32_16x16x32_bf16 a[196:199], a[208:211], v[100:103], a[196:199]
    s_waitcnt lgkmcnt(2)
    ds_read_b64_tr_b16 a[170:171], v2 offset:21000
    v_cvt_pk_bf16_f32 v75, v54, v55
    v_mfma_f32_16x16x32_bf16 a[196:199], a[208:211], v[116:119], a[196:199]
    v_exp_f32 v61, v61
    v_mfma_f32_16x16x32_bf16 v[40:43], a[128:131], a[0:3], v[20:23]
    v_exp_f32 v62, v62
    v_mfma_f32_16x16x32_bf16 v[40:43], a[132:135], a[4:7], v[40:43]
    v_exp_f32 v63, v63
    v_mfma_f32_16x16x32_bf16 v[40:43], a[136:139], a[8:11], v[40:43]
    ds_read_b64_tr_b16 a[172:173], v2 offset:25096
    v_cvt_pk_bf16_f32 v78, v60, v61
    v_mfma_f32_16x16x32_bf16 v[40:43], a[140:143], a[12:15], v[40:43]
    buffer_load_dwordx4 v5, s[24:27], s41 offen offset:1024 nt lds
    v_mfma_f32_16x16x32_bf16 v[44:47], a[140:143], a[28:31], v[24:27]
    v_cvt_pk_bf16_f32 v79, v62, v63
    v_mfma_f32_16x16x32_bf16 v[44:47], a[136:139], a[24:27], v[44:47]
    v_mfma_f32_16x16x32_bf16 v[44:47], a[132:135], a[20:23], v[44:47]
    ds_read_b64_tr_b16 a[174:175], v2 offset:29192
    v_mfma_f32_16x16x32_bf16 v[44:47], a[128:131], a[16:19], v[44:47]
    v_mfma_f32_16x16x32_bf16 v[48:51], a[128:131], a[32:35], v[28:31]
    v_exp_f32 v40, v40
    v_mfma_f32_16x16x32_bf16 v[48:51], a[132:135], a[36:39], v[48:51]
    v_exp_f32 v41, v41
    v_mfma_f32_16x16x32_bf16 v[48:51], a[136:139], a[40:43], v[48:51]
    v_exp_f32 v42, v42
    v_mfma_f32_16x16x32_bf16 v[48:51], a[140:143], a[44:47], v[48:51]
    v_exp_f32 v43, v43
    v_mfma_f32_16x16x32_bf16 v[56:59], a[140:143], a[60:63], v[32:35]
    ds_read_b128 a[144:147], v1 offset:45056
    v_cvt_pk_bf16_f32 v80, v40, v41
    v_mfma_f32_16x16x32_bf16 v[56:59], a[136:139], a[56:59], v[56:59]
    ds_read_b64_tr_b16 a[176:177], v2 offset:17152
    v_cvt_pk_bf16_f32 v81, v42, v43
    v_mfma_f32_16x16x32_bf16 v[56:59], a[132:135], a[52:55], v[56:59]
    s_waitcnt lgkmcnt(2)
    v_exp_f32 v44, v44
    v_mfma_f32_16x16x32_bf16 v[56:59], a[128:131], a[48:51], v[56:59]
    buffer_load_dwordx4 v5, s[24:27], s41 offen offset:2048 nt lds
    v_mfma_f32_16x16x32_bf16 v[192:195], a[160:163], v[96:99], v[192:195]
    ds_read_b128 a[148:151], v1 offset:45312
    v_mfma_f32_16x16x32_bf16 v[192:195], a[164:167], v[112:115], v[192:195]
    ds_read_b64_tr_b16 a[178:179], v2 offset:21248
    v_mfma_f32_16x16x32_bf16 v[196:199], a[164:167], v[116:119], v[196:199]
    s_add_u32 m0, s66, 4096
    v_exp_f32 v45, v45
    v_mfma_f32_16x16x32_bf16 v[196:199], a[160:163], v[100:103], v[196:199]
    v_exp_f32 v46, v46
    v_mfma_f32_16x16x32_bf16 v[200:203], a[160:163], v[104:107], v[200:203]
    ds_read_b128 a[152:155], v1 offset:45568
    v_cvt_pk_bf16_f32 v84, v44, v45
    v_mfma_f32_16x16x32_bf16 v[200:203], a[164:167], v[120:123], v[200:203]
    ds_read_b64_tr_b16 a[180:181], v2 offset:25344
    v_mfma_f32_16x16x32_bf16 v[204:207], a[164:167], v[124:127], v[204:207]
    v_exp_f32 v47, v47
    v_mfma_f32_16x16x32_bf16 v[204:207], a[160:163], v[108:111], v[204:207]
    v_exp_f32 v48, v48
    v_mfma_f32_16x16x32_bf16 v[208:211], a[168:171], v[96:99], v[208:211]
    ds_read_b128 a[156:159], v1 offset:45824
    v_cvt_pk_bf16_f32 v85, v46, v47
    v_mfma_f32_16x16x32_bf16 v[208:211], a[172:175], v[112:115], v[208:211]
    buffer_load_dwordx4 v8, s[68:71], s65 offen offset:3072 nt lds
    v_mfma_f32_16x16x32_bf16 v[212:215], a[172:175], v[116:119], v[212:215]
    ds_read_b64_tr_b16 a[182:183], v2 offset:29440
    v_mfma_f32_16x16x32_bf16 v[212:215], a[168:171], v[100:103], v[212:215]
    v_exp_f32 v49, v49
    v_mfma_f32_16x16x32_bf16 v[216:219], a[168:171], v[104:107], v[216:219]
    ds_read_b64_tr_b16 a[184:185], v2 offset:17160
    v_cvt_pk_bf16_f32 v88, v48, v49
    v_mfma_f32_16x16x32_bf16 v[216:219], a[172:175], v[120:123], v[216:219]
    v_exp_f32 v50, v50
    v_mfma_f32_16x16x32_bf16 v[220:223], a[172:175], v[124:127], v[220:223]
    s_add_u32 m0, s39, 65536
    v_exp_f32 v51, v51
    v_mfma_f32_16x16x32_bf16 v[220:223], a[168:171], v[108:111], v[220:223]
    v_exp_f32 v56, v56
    v_mfma_f32_16x16x32_bf16 a[200:203], a[208:211], v[104:107], a[200:203]
    s_waitcnt lgkmcnt(2)
    ds_read_b64_tr_b16 a[186:187], v2 offset:21256
    v_cvt_pk_bf16_f32 v89, v50, v51
    v_mfma_f32_16x16x32_bf16 a[200:203], a[208:211], v[120:123], a[200:203]
    v_exp_f32 v57, v57
    v_mfma_f32_16x16x32_bf16 v[40:43], a[144:147], a[0:3], v[20:23]
    v_exp_f32 v58, v58
    v_mfma_f32_16x16x32_bf16 v[40:43], a[148:151], a[4:7], v[40:43]
    v_exp_f32 v59, v59
    v_mfma_f32_16x16x32_bf16 v[40:43], a[152:155], a[8:11], v[40:43]
    ds_read_b64_tr_b16 a[188:189], v2 offset:25352
    v_cvt_pk_bf16_f32 v92, v56, v57
    v_mfma_f32_16x16x32_bf16 v[40:43], a[156:159], a[12:15], v[40:43]
    buffer_load_dwordx4 v5, s[24:27], s41 offen offset:3072 nt lds
    v_mfma_f32_16x16x32_bf16 v[44:47], a[156:159], a[28:31], v[24:27]
    v_cvt_pk_bf16_f32 v93, v58, v59
    v_mfma_f32_16x16x32_bf16 v[44:47], a[152:155], a[24:27], v[44:47]
    v_mfma_f32_16x16x32_bf16 v[44:47], a[148:151], a[20:23], v[44:47]
    ds_read_b64_tr_b16 a[190:191], v2 offset:29448
    v_mfma_f32_16x16x32_bf16 v[44:47], a[144:147], a[16:19], v[44:47]
    v_mfma_f32_16x16x32_bf16 v[52:55], a[144:147], a[32:35], v[28:31]
    v_exp_f32 v40, v40
    v_mfma_f32_16x16x32_bf16 v[52:55], a[148:151], a[36:39], v[52:55]
    v_exp_f32 v41, v41
    v_mfma_f32_16x16x32_bf16 v[52:55], a[152:155], a[40:43], v[52:55]
    v_exp_f32 v42, v42
    v_mfma_f32_16x16x32_bf16 v[52:55], a[156:159], a[44:47], v[52:55]
    v_exp_f32 v43, v43
    v_mfma_f32_16x16x32_bf16 v[60:63], a[156:159], a[60:63], v[32:35]
    v_cvt_pk_bf16_f32 v82, v40, v41
    v_cvt_pk_bf16_f32 v83, v42, v43
    v_mfma_f32_16x16x32_bf16 v[60:63], a[152:155], a[56:59], v[60:63]
    s_waitcnt lgkmcnt(0)
    v_exp_f32 v44, v44
    v_mfma_f32_16x16x32_bf16 v[60:63], a[148:151], a[52:55], v[60:63]
    s_waitcnt vmcnt(24)
    v_exp_f32 v45, v45
    v_mfma_f32_16x16x32_bf16 v[60:63], a[144:147], a[48:51], v[60:63]
    s_barrier
    v_mfma_f32_16x16x32_bf16 v[224:227], a[176:179], v[96:99], v[224:227]
    ds_read_b128 a[128:131], v1 offset:49152
    v_cvt_pk_bf16_f32 v86, v44, v45
    v_mfma_f32_16x16x32_bf16 v[224:227], a[180:183], v[112:115], v[224:227]
    ds_read_b64_tr_b16 a[160:161], v2 offset:32768
    v_mfma_f32_16x16x32_bf16 v[228:231], a[180:183], v[116:119], v[228:231]
    s_add_u32 s40, s29, 32768
    ds_read_b128 a[132:135], v1 offset:49408
    v_mfma_f32_16x16x32_bf16 v[228:231], a[176:179], v[100:103], v[228:231]
    s_add_u32 s41, s29, 16384
    ds_read_b64_tr_b16 a[162:163], v2 offset:36864
    v_mfma_f32_16x16x32_bf16 v[232:235], a[176:179], v[104:107], v[232:235]
    s_add_u32 m0, s39, 32768
    ds_read_b128 a[136:139], v1 offset:49664
    v_mfma_f32_16x16x32_bf16 v[232:235], a[180:183], v[120:123], v[232:235]
    ds_read_b64_tr_b16 a[164:165], v2 offset:40960
    v_mfma_f32_16x16x32_bf16 v[236:239], a[180:183], v[124:127], v[236:239]
    v_exp_f32 v46, v46
    v_mfma_f32_16x16x32_bf16 v[236:239], a[176:179], v[108:111], v[236:239]
    v_exp_f32 v47, v47
    v_mfma_f32_16x16x32_bf16 v[240:243], a[184:187], v[96:99], v[240:243]
    ds_read_b128 a[140:143], v1 offset:49920
    v_cvt_pk_bf16_f32 v87, v46, v47
    v_mfma_f32_16x16x32_bf16 v[240:243], a[188:191], v[112:115], v[240:243]
    buffer_load_dwordx4 v5, s[20:23], s40 offen offset:0 nt lds
    v_mfma_f32_16x16x32_bf16 v[244:247], a[188:191], v[116:119], v[244:247]
    ds_read_b64_tr_b16 a[166:167], v2 offset:45056
    v_mfma_f32_16x16x32_bf16 v[244:247], a[184:187], v[100:103], v[244:247]
    v_exp_f32 v52, v52
    v_mfma_f32_16x16x32_bf16 v[248:251], a[184:187], v[104:107], v[248:251]
    ds_read_b64_tr_b16 a[168:169], v2 offset:32776
    v_mfma_f32_16x16x32_bf16 v[248:251], a[188:191], v[120:123], v[248:251]
    v_exp_f32 v53, v53
    v_mfma_f32_16x16x32_bf16 v[252:255], a[188:191], v[124:127], v[252:255]
    v_exp_f32 v54, v54
    v_mfma_f32_16x16x32_bf16 v[252:255], a[184:187], v[108:111], v[252:255]
    v_exp_f32 v55, v55
    v_mfma_f32_16x16x32_bf16 a[204:207], a[208:211], v[108:111], a[204:207]
    s_waitcnt lgkmcnt(2)
    ds_read_b64_tr_b16 a[170:171], v2 offset:36872
    v_cvt_pk_bf16_f32 v90, v52, v53
    v_mfma_f32_16x16x32_bf16 a[204:207], a[208:211], v[124:127], a[204:207]
    v_exp_f32 v60, v60
    v_mfma_f32_16x16x32_bf16 v[40:43], a[128:131], a[0:3], v[20:23]
    v_exp_f32 v61, v61
    v_mfma_f32_16x16x32_bf16 v[40:43], a[132:135], a[4:7], v[40:43]
    v_cvt_pk_bf16_f32 v91, v54, v55
    v_cvt_pk_bf16_f32 v94, v60, v61
    v_mfma_f32_16x16x32_bf16 v[40:43], a[136:139], a[8:11], v[40:43]
    ds_read_b64_tr_b16 a[172:173], v2 offset:40968
    v_mfma_f32_16x16x32_bf16 v[40:43], a[140:143], a[12:15], v[40:43]
    v_exp_f32 v62, v62
    v_mfma_f32_16x16x32_bf16 v[44:47], a[140:143], a[28:31], v[24:27]
    v_exp_f32 v63, v63
    v_mfma_f32_16x16x32_bf16 v[44:47], a[136:139], a[24:27], v[44:47]
    v_cvt_pk_bf16_f32 v95, v62, v63
    v_mfma_f32_16x16x32_bf16 v[44:47], a[132:135], a[20:23], v[44:47]
    ds_read_b64_tr_b16 a[174:175], v2 offset:45064
    v_mfma_f32_16x16x32_bf16 v[44:47], a[128:131], a[16:19], v[44:47]
    buffer_load_dwordx4 v6, s[20:23], s40 offen offset:1024 nt lds
    v_mfma_f32_16x16x32_bf16 v[48:51], a[128:131], a[32:35], v[28:31]
    v_exp_f32 v40, v40
    v_mfma_f32_16x16x32_bf16 v[48:51], a[132:135], a[36:39], v[48:51]
    v_exp_f32 v41, v41
    v_mfma_f32_16x16x32_bf16 v[48:51], a[136:139], a[40:43], v[48:51]
    v_exp_f32 v42, v42
    v_mfma_f32_16x16x32_bf16 v[48:51], a[140:143], a[44:47], v[48:51]
    buffer_store_dwordx4 a[236:239], v4, s[72:75], s77 offen offset:128 nt
    v_mfma_f32_16x16x32_bf16 v[56:59], a[140:143], a[60:63], v[32:35]
    ds_read_b128 a[144:147], v1 offset:53248
    v_cvt_pk_bf16_f32 v96, v40, v41
    v_mfma_f32_16x16x32_bf16 v[56:59], a[136:139], a[56:59], v[56:59]
    s_waitcnt lgkmcnt(1)
    ds_read_b64_tr_b16 a[176:177], v2 offset:33024
    v_mfma_f32_16x16x32_bf16 v[56:59], a[132:135], a[52:55], v[56:59]
    v_exp_f32 v43, v43
    v_mfma_f32_16x16x32_bf16 v[56:59], a[128:131], a[48:51], v[56:59]
    v_exp_f32 v44, v44
    v_mfma_f32_16x16x32_bf16 v[128:131], a[160:163], v[64:67], v[128:131]
    ds_read_b128 a[148:151], v1 offset:53504
    v_cvt_pk_bf16_f32 v97, v42, v43
    v_mfma_f32_16x16x32_bf16 v[128:131], a[164:167], v[80:83], v[128:131]
    ds_read_b64_tr_b16 a[178:179], v2 offset:37120
    v_mfma_f32_16x16x32_bf16 v[132:135], a[164:167], v[84:87], v[132:135]
    v_exp_f32 v45, v45
    v_mfma_f32_16x16x32_bf16 v[132:135], a[160:163], v[68:71], v[132:135]
    v_exp_f32 v46, v46
    v_mfma_f32_16x16x32_bf16 v[136:139], a[160:163], v[72:75], v[136:139]
    ds_read_b128 a[152:155], v1 offset:53760
    v_cvt_pk_bf16_f32 v100, v44, v45
    v_mfma_f32_16x16x32_bf16 v[136:139], a[164:167], v[88:91], v[136:139]
    ds_read_b64_tr_b16 a[180:181], v2 offset:41216
    v_mfma_f32_16x16x32_bf16 v[140:143], a[164:167], v[92:95], v[140:143]
    v_exp_f32 v47, v47
    v_mfma_f32_16x16x32_bf16 v[140:143], a[160:163], v[76:79], v[140:143]
    buffer_load_dwordx4 v7, s[20:23], s40 offen offset:2048 nt lds
    v_mfma_f32_16x16x32_bf16 v[144:147], a[168:171], v[64:67], v[144:147]
    ds_read_b128 a[156:159], v1 offset:54016
    v_cvt_pk_bf16_f32 v101, v46, v47
    v_mfma_f32_16x16x32_bf16 v[144:147], a[172:175], v[80:83], v[144:147]
    ds_read_b64_tr_b16 a[182:183], v2 offset:45312
    v_mfma_f32_16x16x32_bf16 v[148:151], a[172:175], v[84:87], v[148:151]
    v_exp_f32 v48, v48
    v_mfma_f32_16x16x32_bf16 v[148:151], a[168:171], v[68:71], v[148:151]
    v_exp_f32 v49, v49
    v_mfma_f32_16x16x32_bf16 v[152:155], a[168:171], v[72:75], v[152:155]
    ds_read_b64_tr_b16 a[184:185], v2 offset:33032
    v_cvt_pk_bf16_f32 v104, v48, v49
    v_mfma_f32_16x16x32_bf16 v[152:155], a[172:175], v[88:91], v[152:155]
    v_exp_f32 v50, v50
    v_mfma_f32_16x16x32_bf16 v[156:159], a[172:175], v[92:95], v[156:159]
    v_exp_f32 v51, v51
    v_mfma_f32_16x16x32_bf16 v[156:159], a[168:171], v[76:79], v[156:159]
    v_exp_f32 v56, v56
    v_mfma_f32_16x16x32_bf16 a[192:195], a[208:211], v[64:67], a[192:195]
    s_waitcnt lgkmcnt(2)
    ds_read_b64_tr_b16 a[186:187], v2 offset:37128
    v_cvt_pk_bf16_f32 v105, v50, v51
    v_mfma_f32_16x16x32_bf16 a[192:195], a[208:211], v[80:83], a[192:195]
    v_exp_f32 v57, v57
    v_mfma_f32_16x16x32_bf16 v[40:43], a[144:147], a[0:3], v[20:23]
    v_exp_f32 v58, v58
    v_mfma_f32_16x16x32_bf16 v[40:43], a[148:151], a[4:7], v[40:43]
    v_exp_f32 v59, v59
    v_mfma_f32_16x16x32_bf16 v[40:43], a[152:155], a[8:11], v[40:43]
    ds_read_b64_tr_b16 a[188:189], v2 offset:41224
    v_cvt_pk_bf16_f32 v108, v56, v57
    v_mfma_f32_16x16x32_bf16 v[40:43], a[156:159], a[12:15], v[40:43]
    v_cvt_pk_bf16_f32 v109, v58, v59
    v_mfma_f32_16x16x32_bf16 v[44:47], a[156:159], a[28:31], v[24:27]
    v_mfma_f32_16x16x32_bf16 v[44:47], a[152:155], a[24:27], v[44:47]
    v_mfma_f32_16x16x32_bf16 v[44:47], a[148:151], a[20:23], v[44:47]
    ds_read_b64_tr_b16 a[190:191], v2 offset:45320
    v_mfma_f32_16x16x32_bf16 v[44:47], a[144:147], a[16:19], v[44:47]
    buffer_load_dwordx4 v8, s[20:23], s40 offen offset:3072 nt lds
    v_mfma_f32_16x16x32_bf16 v[52:55], a[144:147], a[32:35], v[28:31]
    v_exp_f32 v40, v40
    v_mfma_f32_16x16x32_bf16 v[52:55], a[148:151], a[36:39], v[52:55]
    v_exp_f32 v41, v41
    v_mfma_f32_16x16x32_bf16 v[52:55], a[152:155], a[40:43], v[52:55]
    v_exp_f32 v42, v42
    v_mfma_f32_16x16x32_bf16 v[52:55], a[156:159], a[44:47], v[52:55]
    v_exp_f32 v43, v43
    v_mfma_f32_16x16x32_bf16 v[60:63], a[156:159], a[60:63], v[32:35]
    ds_read_b128 a[128:131], v1 offset:57344
    v_cvt_pk_bf16_f32 v98, v40, v41
    v_mfma_f32_16x16x32_bf16 v[60:63], a[152:155], a[56:59], v[60:63]
    ds_read_b64_tr_b16 a[160:161], v2 offset:33280
    v_cvt_pk_bf16_f32 v99, v42, v43
    v_mfma_f32_16x16x32_bf16 v[60:63], a[148:151], a[52:55], v[60:63]
    s_waitcnt lgkmcnt(2)
    v_exp_f32 v44, v44
    v_mfma_f32_16x16x32_bf16 v[60:63], a[144:147], a[48:51], v[60:63]
    s_add_u32 m0, s39, 81920
    v_exp_f32 v45, v45
    v_mfma_f32_16x16x32_bf16 v[160:163], a[176:179], v[64:67], v[160:163]
    ds_read_b128 a[132:135], v1 offset:57600
    v_cvt_pk_bf16_f32 v102, v44, v45
    v_mfma_f32_16x16x32_bf16 v[160:163], a[180:183], v[80:83], v[160:163]
    ds_read_b64_tr_b16 a[162:163], v2 offset:37376
    v_mfma_f32_16x16x32_bf16 v[164:167], a[180:183], v[84:87], v[164:167]
    v_exp_f32 v46, v46
    v_mfma_f32_16x16x32_bf16 v[164:167], a[176:179], v[68:71], v[164:167]
    buffer_store_dwordx4 a[124:127], v4, s[72:75], s77 offen offset:2048 nt
    v_mfma_f32_16x16x32_bf16 v[168:171], a[176:179], v[72:75], v[168:171]
    ds_read_b128 a[136:139], v1 offset:57856
    v_mfma_f32_16x16x32_bf16 v[168:171], a[180:183], v[88:91], v[168:171]
    ds_read_b64_tr_b16 a[164:165], v2 offset:41472
    v_mfma_f32_16x16x32_bf16 v[172:175], a[180:183], v[92:95], v[172:175]
    v_exp_f32 v47, v47
    v_mfma_f32_16x16x32_bf16 v[172:175], a[176:179], v[76:79], v[172:175]
    buffer_load_dwordx4 v5, s[24:27], s41 offen offset:0 nt lds
    v_mfma_f32_16x16x32_bf16 v[176:179], a[184:187], v[64:67], v[176:179]
    ds_read_b128 a[140:143], v1 offset:58112
    v_cvt_pk_bf16_f32 v103, v46, v47
    v_mfma_f32_16x16x32_bf16 v[176:179], a[188:191], v[80:83], v[176:179]
    ds_read_b64_tr_b16 a[166:167], v2 offset:45568
    v_mfma_f32_16x16x32_bf16 v[180:183], a[188:191], v[84:87], v[180:183]
    v_exp_f32 v52, v52
    v_mfma_f32_16x16x32_bf16 v[180:183], a[184:187], v[68:71], v[180:183]
    v_exp_f32 v53, v53
    v_mfma_f32_16x16x32_bf16 v[184:187], a[184:187], v[72:75], v[184:187]
    ds_read_b64_tr_b16 a[168:169], v2 offset:33288
    v_cvt_pk_bf16_f32 v106, v52, v53
    v_mfma_f32_16x16x32_bf16 v[184:187], a[188:191], v[88:91], v[184:187]
    v_exp_f32 v54, v54
    v_mfma_f32_16x16x32_bf16 v[188:191], a[188:191], v[92:95], v[188:191]
    v_exp_f32 v55, v55
    v_mfma_f32_16x16x32_bf16 v[188:191], a[184:187], v[76:79], v[188:191]
    v_exp_f32 v60, v60
    v_mfma_f32_16x16x32_bf16 a[196:199], a[208:211], v[68:71], a[196:199]
    s_waitcnt lgkmcnt(2)
    ds_read_b64_tr_b16 a[170:171], v2 offset:37384
    v_cvt_pk_bf16_f32 v107, v54, v55
    v_mfma_f32_16x16x32_bf16 a[196:199], a[208:211], v[84:87], a[196:199]
    v_exp_f32 v61, v61
    v_mfma_f32_16x16x32_bf16 v[40:43], a[128:131], a[0:3], v[20:23]
    v_exp_f32 v62, v62
    v_mfma_f32_16x16x32_bf16 v[40:43], a[132:135], a[4:7], v[40:43]
    v_exp_f32 v63, v63
    v_mfma_f32_16x16x32_bf16 v[40:43], a[136:139], a[8:11], v[40:43]
    ds_read_b64_tr_b16 a[172:173], v2 offset:41480
    v_cvt_pk_bf16_f32 v110, v60, v61
    v_mfma_f32_16x16x32_bf16 v[40:43], a[140:143], a[12:15], v[40:43]
    buffer_load_dwordx4 v5, s[24:27], s41 offen offset:1024 nt lds
    v_mfma_f32_16x16x32_bf16 v[44:47], a[140:143], a[28:31], v[24:27]
    v_cvt_pk_bf16_f32 v111, v62, v63
    v_mfma_f32_16x16x32_bf16 v[44:47], a[136:139], a[24:27], v[44:47]
    v_mfma_f32_16x16x32_bf16 v[44:47], a[132:135], a[20:23], v[44:47]
    ds_read_b64_tr_b16 a[174:175], v2 offset:45576
    v_mfma_f32_16x16x32_bf16 v[44:47], a[128:131], a[16:19], v[44:47]
    v_mfma_f32_16x16x32_bf16 v[48:51], a[128:131], a[32:35], v[28:31]
    v_exp_f32 v40, v40
    v_mfma_f32_16x16x32_bf16 v[48:51], a[132:135], a[36:39], v[48:51]
    v_exp_f32 v41, v41
    v_mfma_f32_16x16x32_bf16 v[48:51], a[136:139], a[40:43], v[48:51]
    v_exp_f32 v42, v42
    v_mfma_f32_16x16x32_bf16 v[48:51], a[140:143], a[44:47], v[48:51]
    v_exp_f32 v43, v43
    v_mfma_f32_16x16x32_bf16 v[56:59], a[140:143], a[60:63], v[32:35]
    ds_read_b128 a[144:147], v1 offset:61440
    v_cvt_pk_bf16_f32 v112, v40, v41
    v_mfma_f32_16x16x32_bf16 v[56:59], a[136:139], a[56:59], v[56:59]
    ds_read_b64_tr_b16 a[176:177], v2 offset:33536
    v_cvt_pk_bf16_f32 v113, v42, v43
    v_mfma_f32_16x16x32_bf16 v[56:59], a[132:135], a[52:55], v[56:59]
    s_waitcnt lgkmcnt(2)
    v_exp_f32 v44, v44
    v_mfma_f32_16x16x32_bf16 v[56:59], a[128:131], a[48:51], v[56:59]
    v_exp_f32 v45, v45
    v_mfma_f32_16x16x32_bf16 v[192:195], a[160:163], v[64:67], v[192:195]
    ds_read_b128 a[148:151], v1 offset:61696
    v_cvt_pk_bf16_f32 v116, v44, v45
    v_mfma_f32_16x16x32_bf16 v[192:195], a[164:167], v[80:83], v[192:195]
    ds_read_b64_tr_b16 a[178:179], v2 offset:37632
    v_mfma_f32_16x16x32_bf16 v[196:199], a[164:167], v[84:87], v[196:199]
    v_exp_f32 v46, v46
    v_mfma_f32_16x16x32_bf16 v[196:199], a[160:163], v[68:71], v[196:199]
    buffer_load_dwordx4 v5, s[24:27], s41 offen offset:2048 nt lds
    v_mfma_f32_16x16x32_bf16 v[200:203], a[160:163], v[72:75], v[200:203]
    ds_read_b128 a[152:155], v1 offset:61952
    v_mfma_f32_16x16x32_bf16 v[200:203], a[164:167], v[88:91], v[200:203]
    ds_read_b64_tr_b16 a[180:181], v2 offset:41728
    v_mfma_f32_16x16x32_bf16 v[204:207], a[164:167], v[92:95], v[204:207]
    v_exp_f32 v47, v47
    v_mfma_f32_16x16x32_bf16 v[204:207], a[160:163], v[76:79], v[204:207]
    v_exp_f32 v48, v48
    v_mfma_f32_16x16x32_bf16 v[208:211], a[168:171], v[64:67], v[208:211]
    ds_read_b128 a[156:159], v1 offset:62208
    v_cvt_pk_bf16_f32 v117, v46, v47
    v_mfma_f32_16x16x32_bf16 v[208:211], a[172:175], v[80:83], v[208:211]
    ds_read_b64_tr_b16 a[182:183], v2 offset:45824
    v_mfma_f32_16x16x32_bf16 v[212:215], a[172:175], v[84:87], v[212:215]
    v_exp_f32 v49, v49
    v_mfma_f32_16x16x32_bf16 v[212:215], a[168:171], v[68:71], v[212:215]
    v_exp_f32 v50, v50
    v_mfma_f32_16x16x32_bf16 v[216:219], a[168:171], v[72:75], v[216:219]
    ds_read_b64_tr_b16 a[184:185], v2 offset:33544
    v_cvt_pk_bf16_f32 v120, v48, v49
    v_mfma_f32_16x16x32_bf16 v[216:219], a[172:175], v[88:91], v[216:219]
    buffer_store_dwordx4 a[240:243], v4, s[72:75], s77 offen offset:2176 nt
    v_mfma_f32_16x16x32_bf16 v[220:223], a[172:175], v[92:95], v[220:223]
    v_exp_f32 v51, v51
    v_mfma_f32_16x16x32_bf16 v[220:223], a[168:171], v[76:79], v[220:223]
    s_waitcnt lgkmcnt(2)
    v_exp_f32 v56, v56
    v_mfma_f32_16x16x32_bf16 a[200:203], a[208:211], v[72:75], a[200:203]
    ds_read_b64_tr_b16 a[186:187], v2 offset:37640
    v_cvt_pk_bf16_f32 v121, v50, v51
    v_mfma_f32_16x16x32_bf16 a[200:203], a[208:211], v[88:91], a[200:203]
    v_exp_f32 v57, v57
    v_mfma_f32_16x16x32_bf16 v[40:43], a[144:147], a[0:3], v[20:23]
    v_exp_f32 v58, v58
    v_mfma_f32_16x16x32_bf16 v[40:43], a[148:151], a[4:7], v[40:43]
    v_exp_f32 v59, v59
    v_mfma_f32_16x16x32_bf16 v[40:43], a[152:155], a[8:11], v[40:43]
    ds_read_b64_tr_b16 a[188:189], v2 offset:41736
    v_cvt_pk_bf16_f32 v124, v56, v57
    v_mfma_f32_16x16x32_bf16 v[40:43], a[156:159], a[12:15], v[40:43]
    buffer_load_dwordx4 v5, s[24:27], s41 offen offset:3072 nt lds
    v_mfma_f32_16x16x32_bf16 v[44:47], a[156:159], a[28:31], v[24:27]
    v_cvt_pk_bf16_f32 v125, v58, v59
    v_mfma_f32_16x16x32_bf16 v[44:47], a[152:155], a[24:27], v[44:47]
    v_mfma_f32_16x16x32_bf16 v[44:47], a[148:151], a[20:23], v[44:47]
    ds_read_b64_tr_b16 a[190:191], v2 offset:45832
    v_mfma_f32_16x16x32_bf16 v[44:47], a[144:147], a[16:19], v[44:47]
    v_mfma_f32_16x16x32_bf16 v[52:55], a[144:147], a[32:35], v[28:31]
    v_exp_f32 v40, v40
    v_mfma_f32_16x16x32_bf16 v[52:55], a[148:151], a[36:39], v[52:55]
    s_waitcnt lgkmcnt(0)
    v_exp_f32 v41, v41
    v_mfma_f32_16x16x32_bf16 v[52:55], a[152:155], a[40:43], v[52:55]
    v_exp_f32 v42, v42
    v_mfma_f32_16x16x32_bf16 v[52:55], a[156:159], a[44:47], v[52:55]
    v_exp_f32 v43, v43
    v_mfma_f32_16x16x32_bf16 v[60:63], a[156:159], a[60:63], v[32:35]
    v_exp_f32 v44, v44
    v_mfma_f32_16x16x32_bf16 v[60:63], a[152:155], a[56:59], v[60:63]
    s_waitcnt vmcnt(23)
    v_exp_f32 v45, v45
    v_mfma_f32_16x16x32_bf16 v[60:63], a[148:151], a[52:55], v[60:63]
    v_exp_f32 v46, v46
    v_mfma_f32_16x16x32_bf16 v[60:63], a[144:147], a[48:51], v[60:63]
    s_barrier
    v_mfma_f32_16x16x32_bf16 v[224:227], a[176:179], v[64:67], v[224:227]
    ds_read_b64_tr_b16 a[160:161], v2 offset:49152
    v_cvt_pk_bf16_f32 v114, v40, v41
    v_mfma_f32_16x16x32_bf16 v[224:227], a[180:183], v[80:83], v[224:227]
    ds_read_b64_tr_b16 a[162:163], v2 offset:53248
    v_cvt_pk_bf16_f32 v115, v42, v43
    v_mfma_f32_16x16x32_bf16 v[228:231], a[180:183], v[84:87], v[228:231]
    ds_read_b64_tr_b16 a[164:165], v2 offset:57344
    v_cvt_pk_bf16_f32 v118, v44, v45
    v_mfma_f32_16x16x32_bf16 v[228:231], a[176:179], v[68:71], v[228:231]
    v_exp_f32 v47, v47
    v_mfma_f32_16x16x32_bf16 v[232:235], a[176:179], v[72:75], v[232:235]
    ds_read_b64_tr_b16 a[166:167], v2 offset:61440
    v_cvt_pk_bf16_f32 v119, v46, v47
    v_mfma_f32_16x16x32_bf16 v[232:235], a[180:183], v[88:91], v[232:235]
    v_exp_f32 v52, v52
    v_mfma_f32_16x16x32_bf16 v[236:239], a[180:183], v[92:95], v[236:239]
    v_exp_f32 v53, v53
    v_mfma_f32_16x16x32_bf16 v[236:239], a[176:179], v[76:79], v[236:239]
    v_exp_f32 v54, v54
    v_mfma_f32_16x16x32_bf16 v[240:243], a[184:187], v[64:67], v[240:243]
    ds_read_b64_tr_b16 a[168:169], v2 offset:49160
    v_cvt_pk_bf16_f32 v122, v52, v53
    v_mfma_f32_16x16x32_bf16 v[240:243], a[188:191], v[80:83], v[240:243]
    v_exp_f32 v55, v55
    v_mfma_f32_16x16x32_bf16 v[244:247], a[188:191], v[84:87], v[244:247]
    v_cvt_pk_bf16_f32 v123, v54, v55
    v_mfma_f32_16x16x32_bf16 v[244:247], a[184:187], v[68:71], v[244:247]
    v_mfma_f32_16x16x32_bf16 v[248:251], a[184:187], v[72:75], v[248:251]
    ds_read_b64_tr_b16 a[170:171], v2 offset:53256
    v_mfma_f32_16x16x32_bf16 v[248:251], a[188:191], v[88:91], v[248:251]
    v_mfma_f32_16x16x32_bf16 v[252:255], a[188:191], v[92:95], v[252:255]
    v_mfma_f32_16x16x32_bf16 v[252:255], a[184:187], v[76:79], v[252:255]
    v_mfma_f32_16x16x32_bf16 a[204:207], a[208:211], v[76:79], a[204:207]
    ds_read_b64_tr_b16 a[172:173], v2 offset:57352
    v_mfma_f32_16x16x32_bf16 a[204:207], a[208:211], v[92:95], a[204:207]
    ds_read_b64_tr_b16 a[174:175], v2 offset:61448
    s_cmp_eq_u32 s37, 3
    s_cbranch_scc1 L_final
    v_mfma_f32_16x16x32_bf16 v[64:67], a[246:249], a[64:67], 0
    s_waitcnt vmcnt(12)
    ds_read_b128 a[32:35], v9 offset:0
    v_mfma_f32_16x16x32_bf16 v[64:67], a[250:253], a[64:67], v[64:67]
    s_mov_b64 s[76:77], s[32:33]
    ds_read_b128 a[36:39], v9 offset:256
    s_nop 0
    v_mfma_f32_16x16x32_bf16 v[68:71], a[244:247], a[64:67], 0
    s_add_u32 s40, s29, 49152
    ds_read_b64_tr_b16 a[176:177], v2 offset:49408
    s_nop 0
    v_mfma_f32_16x16x32_bf16 v[68:71], a[248:251], a[64:67], v[68:71]
    s_add_u32 m0, s39, 49152
    ds_read_b128 a[40:43], v9 offset:512
    v_cvt_pk_bf16_f32 v64, v64, v65
    v_mfma_f32_16x16x32_bf16 v[72:75], a[246:249], a[68:71], 0
    s_mov_b32 s28, s29
    v_exp_f32 v60, v60
    v_mfma_f32_16x16x32_bf16 v[72:75], a[250:253], a[68:71], v[72:75]
    v_exp_f32 v61, v61
    v_mfma_f32_16x16x32_bf16 v[76:79], a[244:247], a[68:71], 0
    ds_read_b64_tr_b16 a[178:179], v2 offset:53504
    v_cvt_pk_bf16_f32 v126, v60, v61
    v_mfma_f32_16x16x32_bf16 v[76:79], a[248:251], a[68:71], v[76:79]
    v_exp_f32 v62, v62
    v_mfma_f32_16x16x32_bf16 v[80:83], a[246:249], a[72:75], 0
    v_exp_f32 v63, v63
    v_mfma_f32_16x16x32_bf16 v[80:83], a[250:253], a[72:75], v[80:83]
    buffer_load_dwordx4 v5, s[20:23], s40 offen offset:0 nt lds
    v_mfma_f32_16x16x32_bf16 v[84:87], a[244:247], a[72:75], 0
    ds_read_b64_tr_b16 a[180:181], v2 offset:57600
    v_cvt_pk_bf16_f32 v127, v62, v63
    v_mfma_f32_16x16x32_bf16 v[84:87], a[248:251], a[72:75], v[84:87]
    ds_read_b128 a[44:47], v9 offset:768
    v_cvt_pk_bf16_f32 v66, v66, v67
    v_mfma_f32_16x16x32_bf16 v[88:91], a[246:249], a[76:79], 0
    ds_read_b128 a[48:51], v9 offset:4096
    v_accvgpr_write_b32 a0, v64
    v_mfma_f32_16x16x32_bf16 v[88:91], a[250:253], a[76:79], v[88:91]
    ds_read_b128 a[52:55], v9 offset:4352
    v_accvgpr_write_b32 a1, v66
    v_mfma_f32_16x16x32_bf16 v[92:95], a[244:247], a[76:79], 0
    ds_read_b64_tr_b16 a[182:183], v2 offset:61696
    v_cvt_pk_bf16_f32 v68, v68, v69
    v_mfma_f32_16x16x32_bf16 v[92:95], a[248:251], a[76:79], v[92:95]
    ds_read_b128 a[56:59], v9 offset:4608
    v_cvt_pk_bf16_f32 v70, v70, v71
    v_accvgpr_write_b32 a2, v68
    v_accvgpr_write_b32 a3, v70
    v_mfma_f32_16x16x32_bf16 a[192:195], a[208:211], v[96:99], a[192:195]
    ds_read_b128 a[60:63], v9 offset:4864
    v_cvt_pk_bf16_f32 v72, v72, v73
    v_mfma_f32_16x16x32_bf16 a[192:195], a[208:211], v[112:115], a[192:195]
    v_cvt_pk_bf16_f32 v74, v74, v75
    v_accvgpr_write_b32 a4, v72
    v_accvgpr_write_b32 a5, v74
    v_mfma_f32_16x16x32_bf16 a[196:199], a[208:211], v[100:103], a[196:199]
    s_waitcnt lgkmcnt(12)
    ds_read_b64_tr_b16 a[184:185], v2 offset:49416
    v_cvt_pk_bf16_f32 v76, v76, v77
    v_mfma_f32_16x16x32_bf16 a[196:199], a[208:211], v[116:119], a[196:199]
    v_accvgpr_read_b32 v14, a192
    v_cmp_nge_f32 s[48:49], s36, v14
    v_rcp_f32 v14, v14
    v_mfma_f32_16x16x32_bf16 a[200:203], a[208:211], v[104:107], a[200:203]
    v_cvt_pk_bf16_f32 v78, v78, v79
    v_accvgpr_write_b32 a6, v76
    v_mfma_f32_16x16x32_bf16 a[200:203], a[208:211], v[120:123], a[200:203]
    v_accvgpr_write_b32 a7, v78
    v_accvgpr_read_b32 v15, a196
    v_mfma_f32_16x16x32_bf16 a[204:207], a[208:211], v[108:111], a[204:207]
    ds_read_b64_tr_b16 a[186:187], v2 offset:53512
    v_cmp_nge_f32 s[50:51], s36, v15
    v_mfma_f32_16x16x32_bf16 a[204:207], a[208:211], v[124:127], a[204:207]
    v_rcp_f32 v15, v15
    v_mfma_f32_16x16x32_bf16 v[128:131], a[160:163], v[96:99], v[128:131]
    v_accvgpr_read_b32 v16, a200
    v_cmp_nge_f32 s[52:53], s36, v16
    v_mfma_f32_16x16x32_bf16 v[128:131], a[164:167], v[112:115], v[128:131]
    v_rcp_f32 v16, v16
    v_mfma_f32_16x16x32_bf16 v[132:135], a[164:167], v[116:119], v[132:135]
    ds_read_b64_tr_b16 a[188:189], v2 offset:57608
    v_accvgpr_read_b32 v17, a204
    v_mfma_f32_16x16x32_bf16 v[132:135], a[160:163], v[100:103], v[132:135]
    buffer_load_dwordx4 v6, s[20:23], s40 offen offset:1024 nt lds
    v_mfma_f32_16x16x32_bf16 v[136:139], a[160:163], v[104:107], v[136:139]
    v_cmp_nge_f32 s[54:55], s36, v17
    v_mul_f32 v128, v128, v14
    v_mfma_f32_16x16x32_bf16 v[136:139], a[164:167], v[120:123], v[136:139]
    v_mul_f32 v129, v129, v14
    v_mul_f32 v130, v130, v14
    v_mul_f32 v131, v131, v14
    v_cvt_pk_bf16_f32 v128, v128, v129
    v_cvt_pk_bf16_f32 v129, v130, v131
    v_mul_f32 v132, v132, v15
    v_mul_f32 v133, v133, v15
    v_mul_f32 v134, v134, v15
    v_mul_f32 v135, v135, v15
    v_cvt_pk_bf16_f32 v132, v132, v133
    v_cvt_pk_bf16_f32 v133, v134, v135
    v_mul_f32 v136, v136, v16
    v_mul_f32 v137, v137, v16
    v_mul_f32 v138, v138, v16
    v_mul_f32 v139, v139, v16
    v_cvt_pk_bf16_f32 v136, v136, v137
    v_cvt_pk_bf16_f32 v137, v138, v139
    v_mfma_f32_16x16x32_bf16 v[140:143], a[164:167], v[124:127], v[140:143]
    ds_read_b64_tr_b16 a[190:191], v2 offset:61704
    v_cvt_pk_bf16_f32 v80, v80, v81
    v_mfma_f32_16x16x32_bf16 v[140:143], a[160:163], v[108:111], v[140:143]
    v_rcp_f32 v17, v17
    v_mfma_f32_16x16x32_bf16 v[144:147], a[168:171], v[96:99], v[144:147]
    v_cvt_pk_bf16_f32 v82, v82, v83
    v_accvgpr_write_b32 a8, v80
    v_mfma_f32_16x16x32_bf16 v[144:147], a[172:175], v[112:115], v[144:147]
    v_accvgpr_write_b32 a9, v82
    v_cvt_pk_bf16_f32 v84, v84, v85
    v_mfma_f32_16x16x32_bf16 v[148:151], a[172:175], v[116:119], v[148:151]
    ds_read_b64_tr_b16 a[160:161], v2 offset:49664
    v_mul_f32 v140, v140, v17
    v_mfma_f32_16x16x32_bf16 v[148:151], a[168:171], v[100:103], v[148:151]
    v_mul_f32 v141, v141, v17
    v_mul_f32 v142, v142, v17
    v_mul_f32 v144, v144, v14
    v_mul_f32 v145, v145, v14
    v_mul_f32 v146, v146, v14
    v_mfma_f32_16x16x32_bf16 v[152:155], a[168:171], v[104:107], v[152:155]
    v_mul_f32 v147, v147, v14
    v_cvt_pk_bf16_f32 v130, v144, v145
    v_mfma_f32_16x16x32_bf16 v[152:155], a[172:175], v[120:123], v[152:155]
    s_waitcnt lgkmcnt(1)
    v_cvt_pk_bf16_f32 v131, v146, v147
    v_mul_f32 v148, v148, v15
    v_mul_f32 v149, v149, v15
    v_mul_f32 v150, v150, v15
    v_mfma_f32_16x16x32_bf16 v[156:159], a[172:175], v[124:127], v[156:159]
    ds_read_b64_tr_b16 a[162:163], v2 offset:53760
    v_mul_f32 v151, v151, v15
    v_mfma_f32_16x16x32_bf16 v[156:159], a[168:171], v[108:111], v[156:159]
    ds_write_b128 v12, v[128:131] offset:0
    v_cvt_pk_bf16_f32 v134, v148, v149
    v_cvt_pk_bf16_f32 v135, v150, v151
    v_mul_f32 v152, v152, v16
    v_mul_f32 v153, v153, v16
    v_mul_f32 v154, v154, v16
    v_mfma_f32_16x16x32_bf16 v[160:163], a[176:179], v[96:99], v[160:163]
    v_mul_f32 v155, v155, v16
    v_cvt_pk_bf16_f32 v138, v152, v153
    v_mfma_f32_16x16x32_bf16 v[160:163], a[180:183], v[112:115], v[160:163]
    ds_write_b128 v12, v[132:135] offset:2048
    v_cvt_pk_bf16_f32 v139, v154, v155
    v_mul_f32 v143, v143, v17
    v_mul_f32 v156, v156, v17
    v_mfma_f32_16x16x32_bf16 v[164:167], a[180:183], v[116:119], v[164:167]
    ds_read_b64_tr_b16 a[164:165], v2 offset:57856
    v_mul_f32 v157, v157, v17
    v_mfma_f32_16x16x32_bf16 v[164:167], a[176:179], v[100:103], v[164:167]
    ds_write_b128 v12, v[136:139] offset:4096
    v_mul_f32 v160, v160, v14
    v_mul_f32 v161, v161, v14
    v_mul_f32 v162, v162, v14
    v_mul_f32 v163, v163, v14
    v_mfma_f32_16x16x32_bf16 v[168:171], a[176:179], v[104:107], v[168:171]
    v_mul_f32 v158, v158, v17
    v_mul_f32 v159, v159, v17
    v_mfma_f32_16x16x32_bf16 v[168:171], a[180:183], v[120:123], v[168:171]
    buffer_load_dwordx4 v7, s[20:23], s40 offen offset:2048 nt lds
    v_cvt_pk_bf16_f32 v140, v140, v141
    v_cvt_pk_bf16_f32 v141, v142, v143
    v_cvt_pk_bf16_f32 v142, v156, v157
    v_cvt_pk_bf16_f32 v160, v160, v161
    v_cvt_pk_bf16_f32 v143, v158, v159
    v_cvt_pk_bf16_f32 v161, v162, v163
    v_mfma_f32_16x16x32_bf16 v[172:175], a[180:183], v[124:127], v[172:175]
    ds_read_b64_tr_b16 a[166:167], v2 offset:61952
    v_mul_f32 v164, v164, v15
    v_mfma_f32_16x16x32_bf16 v[172:175], a[176:179], v[108:111], v[172:175]
    ds_write_b128 v12, v[140:143] offset:6144
    v_mul_f32 v165, v165, v15
    v_cvt_pk_bf16_f32 v86, v86, v87
    v_mul_f32 v166, v166, v15
    v_accvgpr_write_b32 a10, v84
    v_accvgpr_write_b32 a11, v86
    v_mfma_f32_16x16x32_bf16 v[176:179], a[184:187], v[96:99], v[176:179]
    v_mul_f32 v167, v167, v15
    v_cvt_pk_bf16_f32 v88, v88, v89
    v_mfma_f32_16x16x32_bf16 v[176:179], a[188:191], v[112:115], v[176:179]
    v_cvt_pk_bf16_f32 v90, v90, v91
    v_accvgpr_write_b32 a12, v88
    v_accvgpr_write_b32 a13, v90
    v_cvt_pk_bf16_f32 v164, v164, v165
    v_cvt_pk_bf16_f32 v165, v166, v167
    v_mfma_f32_16x16x32_bf16 v[180:183], a[188:191], v[116:119], v[180:183]
    ds_read_b64_tr_b16 a[168:169], v2 offset:49672
    v_cvt_pk_bf16_f32 v92, v92, v93
    v_mfma_f32_16x16x32_bf16 v[180:183], a[184:187], v[100:103], v[180:183]
    v_mul_f32 v176, v176, v14
    v_mul_f32 v177, v177, v14
    v_mul_f32 v178, v178, v14
    v_mul_f32 v179, v179, v14
    v_cvt_pk_bf16_f32 v162, v176, v177
    v_cvt_pk_bf16_f32 v163, v178, v179
    v_mfma_f32_16x16x32_bf16 v[184:187], a[184:187], v[104:107], v[184:187]
    v_cvt_pk_bf16_f32 v94, v94, v95
    v_mul_f32 v180, v180, v15
    v_mfma_f32_16x16x32_bf16 v[184:187], a[188:191], v[120:123], v[184:187]
    ds_write_b128 v13, v[160:163] offset:0
    v_mul_f32 v181, v181, v15
    v_mul_f32 v182, v182, v15
    v_mul_f32 v183, v183, v15
    v_cvt_pk_bf16_f32 v166, v180, v181
    v_cvt_pk_bf16_f32 v167, v182, v183
    v_mfma_f32_16x16x32_bf16 v[188:191], a[188:191], v[124:127], v[188:191]
    ds_read_b64_tr_b16 a[170:171], v2 offset:53768
    v_accvgpr_write_b32 a14, v92
    v_mfma_f32_16x16x32_bf16 v[188:191], a[184:187], v[108:111], v[188:191]
    ds_write_b128 v13, v[164:167] offset:2048
    v_accvgpr_write_b32 a15, v94
    v_mul_f32 v168, v168, v16
    v_mul_f32 v169, v169, v16
    v_mul_f32 v170, v170, v16
    v_mfma_f32_16x16x32_bf16 v[64:67], a[246:249], a[80:83], 0
    ds_read_b128 a[96:99], v11 offset:0
    v_mul_f32 v171, v171, v16
    v_mfma_f32_16x16x32_bf16 v[64:67], a[250:253], a[80:83], v[64:67]
    ds_read_b128 a[100:103], v11 offset:1024
    v_mul_f32 v184, v184, v16
    v_mul_f32 v185, v185, v16
    v_mul_f32 v186, v186, v16
    v_mfma_f32_16x16x32_bf16 v[68:71], a[244:247], a[80:83], 0
    ds_read_b64_tr_b16 a[172:173], v2 offset:57864
    v_mul_f32 v187, v187, v16
    v_mfma_f32_16x16x32_bf16 v[68:71], a[248:251], a[80:83], v[68:71]
    ds_read_b128 a[104:107], v11 offset:2048
    v_cvt_pk_bf16_f32 v168, v168, v169
    v_cvt_pk_bf16_f32 v169, v170, v171
    v_cvt_pk_bf16_f32 v170, v184, v185
    v_cvt_pk_bf16_f32 v171, v186, v187
    v_mfma_f32_16x16x32_bf16 v[72:75], a[246:249], a[84:87], 0
    ds_read_b128 a[108:111], v11 offset:3072
    v_mul_f32 v172, v172, v17
    v_mfma_f32_16x16x32_bf16 v[72:75], a[250:253], a[84:87], v[72:75]
    buffer_load_dwordx4 v8, s[20:23], s40 offen offset:3072 nt lds
    v_mul_f32 v173, v173, v17
    v_mul_f32 v174, v174, v17
    v_mfma_f32_16x16x32_bf16 v[76:79], a[244:247], a[84:87], 0
    ds_read_b64_tr_b16 a[174:175], v2 offset:61960
    v_mul_f32 v175, v175, v17
    v_mfma_f32_16x16x32_bf16 v[76:79], a[248:251], a[84:87], v[76:79]
    ds_write_b128 v13, v[168:171] offset:4096
    v_cvt_pk_bf16_f32 v172, v172, v173
    v_mul_f32 v188, v188, v17
    v_mfma_f32_16x16x32_bf16 v[80:83], a[246:249], a[88:91], 0
    ds_read_b128 a[112:115], v11 offset:4096
    v_mul_f32 v189, v189, v17
    v_mfma_f32_16x16x32_bf16 v[80:83], a[250:253], a[88:91], v[80:83]
    ds_read_b128 a[116:119], v11 offset:5120
    v_mul_f32 v190, v190, v17
    v_mfma_f32_16x16x32_bf16 v[84:87], a[244:247], a[88:91], 0
    v_mul_f32 v191, v191, v17
    v_cvt_pk_bf16_f32 v173, v174, v175
    v_mfma_f32_16x16x32_bf16 v[84:87], a[248:251], a[88:91], v[84:87]
    v_cvt_pk_bf16_f32 v174, v188, v189
    v_cvt_pk_bf16_f32 v175, v190, v191
    v_mfma_f32_16x16x32_bf16 v[88:91], a[246:249], a[92:95], 0
    v_cvt_pk_bf16_f32 v64, v64, v65
    v_cvt_pk_bf16_f32 v66, v66, v67
    v_mfma_f32_16x16x32_bf16 v[88:91], a[250:253], a[92:95], v[88:91]
    s_waitcnt lgkmcnt(3)
    ds_write_b128 v13, v[172:175] offset:6144
    v_accvgpr_write_b32 a16, v64
    v_accvgpr_write_b32 a17, v66
    v_mfma_f32_16x16x32_bf16 v[92:95], a[244:247], a[92:95], 0
    ds_read_b128 a[120:123], v11 offset:6144
    v_cvt_pk_bf16_f32 v68, v68, v69
    v_mfma_f32_16x16x32_bf16 v[92:95], a[248:251], a[92:95], v[92:95]
    ds_read_b128 a[124:127], v11 offset:7168
    v_cvt_pk_bf16_f32 v70, v70, v71
    v_accvgpr_write_b32 a18, v68
    v_accvgpr_write_b32 a19, v70
    v_mfma_f32_16x16x32_bf16 v[192:195], a[160:163], v[96:99], v[192:195]
    v_cvt_pk_bf16_f32 v72, v72, v73
    v_cvt_pk_bf16_f32 v74, v74, v75
    v_mfma_f32_16x16x32_bf16 v[192:195], a[164:167], v[112:115], v[192:195]
    s_add_u32 s41, s29, 32768
    v_accvgpr_write_b32 a20, v72
    v_accvgpr_write_b32 a21, v74
    v_mfma_f32_16x16x32_bf16 v[196:199], a[164:167], v[116:119], v[196:199]
    s_add_u32 m0, s39, 98304
    v_cvt_pk_bf16_f32 v76, v76, v77
    v_cvt_pk_bf16_f32 v78, v78, v79
    v_mfma_f32_16x16x32_bf16 v[196:199], a[160:163], v[100:103], v[196:199]
    s_or_b64 s[48:49], s[48:49], s[50:51]
    v_mul_f32 v192, v192, v14
    v_mul_f32 v193, v193, v14
    v_mul_f32 v194, v194, v14
    v_mul_f32 v195, v195, v14
    v_accvgpr_write_b32 a22, v76
    v_mfma_f32_16x16x32_bf16 v[200:203], a[160:163], v[104:107], v[200:203]
    s_or_b64 s[52:53], s[52:53], s[54:55]
    v_accvgpr_write_b32 a23, v78
    v_cvt_pk_bf16_f32 v192, v192, v193
    v_mfma_f32_16x16x32_bf16 v[200:203], a[164:167], v[120:123], v[200:203]
    s_or_b64 s[48:49], s[48:49], s[52:53]
    v_cvt_pk_bf16_f32 v193, v194, v195
    v_cvt_pk_bf16_f32 v80, v80, v81
    v_cvt_pk_bf16_f32 v82, v82, v83
    v_accvgpr_write_b32 a24, v80
    v_accvgpr_write_b32 a25, v82
    v_mfma_f32_16x16x32_bf16 v[204:207], a[164:167], v[124:127], v[204:207]
    s_cselect_b32 s42, 1, 0
    v_mul_f32 v196, v196, v15
    v_mul_f32 v197, v197, v15
    v_mfma_f32_16x16x32_bf16 v[204:207], a[160:163], v[108:111], v[204:207]
    s_lshl_b32 s42, s42, s37
    buffer_load_dwordx4 v5, s[24:27], s41 offen offset:0 nt lds
    v_cvt_pk_bf16_f32 v84, v84, v85
    v_cvt_pk_bf16_f32 v86, v86, v87
    v_mul_f32 v198, v198, v15
    v_accvgpr_write_b32 a26, v84
    v_accvgpr_write_b32 a27, v86
    v_mfma_f32_16x16x32_bf16 v[208:211], a[168:171], v[96:99], v[208:211]
    s_or_b32 s38, s38, s42
    v_mul_f32 v199, v199, v15
    v_cvt_pk_bf16_f32 v88, v88, v89
    v_mfma_f32_16x16x32_bf16 v[208:211], a[172:175], v[112:115], v[208:211]
    s_add_u32 s37, s37, 1
    v_cvt_pk_bf16_f32 v90, v90, v91
    v_accvgpr_write_b32 a28, v88
    v_accvgpr_write_b32 a29, v90
    v_cvt_pk_bf16_f32 v196, v196, v197
    v_cvt_pk_bf16_f32 v197, v198, v199
    v_mfma_f32_16x16x32_bf16 v[212:215], a[172:175], v[116:119], v[212:215]
    s_waitcnt lgkmcnt(15)
    v_mul_f32 v208, v208, v14
    v_mul_f32 v209, v209, v14
    v_mfma_f32_16x16x32_bf16 v[212:215], a[168:171], v[100:103], v[212:215]
    s_cselect_b32 s74, 0, 65011712
    v_mul_f32 v210, v210, v14
    v_mul_f32 v211, v211, v14
    v_cvt_pk_bf16_f32 v194, v208, v209
    v_cvt_pk_bf16_f32 v195, v210, v211
    v_mfma_f32_16x16x32_bf16 v[216:219], a[168:171], v[104:107], v[216:219]
    s_cmp_lt_u32 s37, 3
    v_cvt_pk_bf16_f32 v92, v92, v93
    v_mul_f32 v212, v212, v15
    v_mfma_f32_16x16x32_bf16 v[216:219], a[172:175], v[120:123], v[216:219]
    s_cselect_b32 s42, 253952, 0
    ds_write_b128 v12, v[192:195] offset:0
    v_mul_f32 v213, v213, v15
    v_mul_f32 v214, v214, v15
    v_mul_f32 v215, v215, v15
    v_cvt_pk_bf16_f32 v198, v212, v213
    v_cvt_pk_bf16_f32 v199, v214, v215
    v_mfma_f32_16x16x32_bf16 v[220:223], a[172:175], v[124:127], v[220:223]
    s_cselect_b32 s45, 131072, 0
    v_cvt_pk_bf16_f32 v94, v94, v95
    v_accvgpr_write_b32 a30, v92
    v_mfma_f32_16x16x32_bf16 v[220:223], a[168:171], v[108:111], v[220:223]
    s_cselect_b32 s6, s6, 0
    ds_write_b128 v12, v[196:199] offset:2048
    v_accvgpr_write_b32 a31, v94
    v_mul_f32 v200, v200, v16
    v_mul_f32 v201, v201, v16
    v_mul_f32 v202, v202, v16
    v_mfma_f32_16x16x32_bf16 v[64:67], a[246:249], a[32:35], 0
    s_cselect_b32 s70, s70, 0
    v_mul_f32 v203, v203, v16
    v_mul_f32 v216, v216, v16
    v_mfma_f32_16x16x32_bf16 v[64:67], a[250:253], a[32:35], v[64:67]
    v_mul_f32 v217, v217, v16
    v_mul_f32 v218, v218, v16
    v_mfma_f32_16x16x32_bf16 v[68:71], a[244:247], a[32:35], 0
    v_mul_f32 v219, v219, v16
    v_cvt_pk_bf16_f32 v200, v200, v201
    v_mfma_f32_16x16x32_bf16 v[68:71], a[248:251], a[32:35], v[68:71]
    v_cvt_pk_bf16_f32 v201, v202, v203
    v_cvt_pk_bf16_f32 v202, v216, v217
    v_cvt_pk_bf16_f32 v64, v64, v65
    v_cvt_pk_bf16_f32 v66, v66, v67
    v_accvgpr_write_b32 a32, v64
    v_mfma_f32_16x16x32_bf16 v[72:75], a[246:249], a[36:39], 0
    v_accvgpr_write_b32 a33, v66
    v_cvt_pk_bf16_f32 v203, v218, v219
    v_mfma_f32_16x16x32_bf16 v[72:75], a[250:253], a[36:39], v[72:75]
    ds_write_b128 v12, v[200:203] offset:4096
    v_mfma_f32_16x16x32_bf16 v[76:79], a[244:247], a[36:39], 0
    v_cvt_pk_bf16_f32 v68, v68, v69
    v_cvt_pk_bf16_f32 v70, v70, v71
    v_mfma_f32_16x16x32_bf16 v[76:79], a[248:251], a[36:39], v[76:79]
    s_waitcnt lgkmcnt(3)
    buffer_store_dwordx4 a[96:99], v3, s[16:19], s32 offen offset:0 nt
    v_mfma_f32_16x16x32_bf16 v[80:83], a[246:249], a[40:43], 0
    v_accvgpr_write_b32 a34, v68
    v_accvgpr_write_b32 a35, v70
    v_mfma_f32_16x16x32_bf16 v[80:83], a[250:253], a[40:43], v[80:83]
    v_mul_f32 v204, v204, v17
    v_mul_f32 v205, v205, v17
    v_cvt_pk_bf16_f32 v72, v72, v73
    v_cvt_pk_bf16_f32 v74, v74, v75
    v_mul_f32 v206, v206, v17
    v_mfma_f32_16x16x32_bf16 v[84:87], a[244:247], a[40:43], 0
    ds_read_b128 a[128:131], v1 offset:0
    v_accvgpr_write_b32 a36, v72
    v_mfma_f32_16x16x32_bf16 v[84:87], a[248:251], a[40:43], v[84:87]
    buffer_load_dwordx4 v5, s[24:27], s41 offen offset:1024 nt lds
    v_accvgpr_write_b32 a37, v74
    v_mfma_f32_16x16x32_bf16 v[88:91], a[246:249], a[44:47], 0
    ds_read_b64_tr_b16 a[176:177], v2 offset:49920
    v_mul_f32 v207, v207, v17
    v_mfma_f32_16x16x32_bf16 v[88:91], a[250:253], a[44:47], v[88:91]
    v_mul_f32 v220, v220, v17
    v_mul_f32 v221, v221, v17
    v_mfma_f32_16x16x32_bf16 v[92:95], a[244:247], a[44:47], 0
    ds_read_b128 a[132:135], v1 offset:256
    v_mul_f32 v222, v222, v17
    v_mfma_f32_16x16x32_bf16 v[92:95], a[248:251], a[44:47], v[92:95]
    ds_read_b64_tr_b16 a[178:179], v2 offset:54016
    v_mul_f32 v223, v223, v17
    v_mfma_f32_16x16x32_bf16 v[64:67], a[246:249], a[48:51], 0
    v_cvt_pk_bf16_f32 v76, v76, v77
    v_cvt_pk_bf16_f32 v78, v78, v79
    v_mfma_f32_16x16x32_bf16 v[64:67], a[250:253], a[48:51], v[64:67]
    v_accvgpr_write_b32 a38, v76
    v_accvgpr_write_b32 a39, v78
    v_mfma_f32_16x16x32_bf16 v[68:71], a[244:247], a[48:51], 0
    ds_read_b128 a[136:139], v1 offset:512
    v_cvt_pk_bf16_f32 v204, v204, v205
    v_mfma_f32_16x16x32_bf16 v[68:71], a[248:251], a[48:51], v[68:71]
    ds_read_b64_tr_b16 a[180:181], v2 offset:58112
    v_cvt_pk_bf16_f32 v205, v206, v207
    v_cvt_pk_bf16_f32 v206, v220, v221
    v_cvt_pk_bf16_f32 v207, v222, v223
    v_mfma_f32_16x16x32_bf16 v[72:75], a[246:249], a[52:55], 0
    v_cvt_pk_bf16_f32 v80, v80, v81
    v_cvt_pk_bf16_f32 v82, v82, v83
    v_mfma_f32_16x16x32_bf16 v[72:75], a[250:253], a[52:55], v[72:75]
    ds_write_b128 v12, v[204:207] offset:6144
    v_accvgpr_write_b32 a40, v80
    v_accvgpr_write_b32 a41, v82
    v_mfma_f32_16x16x32_bf16 v[76:79], a[244:247], a[52:55], 0
    ds_read_b128 a[140:143], v1 offset:768
    v_cvt_pk_bf16_f32 v84, v84, v85
    v_mfma_f32_16x16x32_bf16 v[76:79], a[248:251], a[52:55], v[76:79]
    buffer_store_dwordx4 a[100:103], v3, s[16:19], s32 offen offset:2048 nt
    v_cvt_pk_bf16_f32 v86, v86, v87
    v_accvgpr_write_b32 a42, v84
    v_accvgpr_write_b32 a43, v86
    v_mfma_f32_16x16x32_bf16 v[80:83], a[246:249], a[56:59], 0
    ds_read_b64_tr_b16 a[182:183], v2 offset:62208
    v_cvt_pk_bf16_f32 v88, v88, v89
    v_mfma_f32_16x16x32_bf16 v[80:83], a[250:253], a[56:59], v[80:83]
    v_cvt_pk_bf16_f32 v90, v90, v91
    v_accvgpr_write_b32 a44, v88
    v_accvgpr_write_b32 a45, v90
    v_mfma_f32_16x16x32_bf16 v[84:87], a[244:247], a[56:59], 0
    ds_read_b64_tr_b16 a[184:185], v2 offset:49928
    v_cvt_pk_bf16_f32 v92, v92, v93
    v_mfma_f32_16x16x32_bf16 v[84:87], a[248:251], a[56:59], v[84:87]
    buffer_load_dwordx4 v5, s[24:27], s41 offen offset:2048 nt lds
    v_cvt_pk_bf16_f32 v94, v94, v95
    v_accvgpr_write_b32 a46, v92
    v_accvgpr_write_b32 a47, v94
    v_mfma_f32_16x16x32_bf16 v[88:91], a[246:249], a[60:63], 0
    s_waitcnt lgkmcnt(2)
    v_cvt_pk_bf16_f32 v80, v80, v81
    v_cvt_pk_bf16_f32 v82, v82, v83
    v_mfma_f32_16x16x32_bf16 v[88:91], a[250:253], a[60:63], v[88:91]
    v_cvt_pk_bf16_f32 v84, v84, v85
    v_cvt_pk_bf16_f32 v86, v86, v87
    v_accvgpr_write_b32 a56, v80
    v_accvgpr_write_b32 a57, v82
    v_mfma_f32_16x16x32_bf16 v[92:95], a[244:247], a[60:63], 0
    ds_read_b64_tr_b16 a[186:187], v2 offset:54024
    v_accvgpr_write_b32 a58, v84
    v_mfma_f32_16x16x32_bf16 v[92:95], a[248:251], a[60:63], v[92:95]
    v_cvt_pk_bf16_f32 v88, v88, v89
    v_cvt_pk_bf16_f32 v90, v90, v91
    v_accvgpr_write_b32 a60, v88
    v_mfma_f32_16x16x32_bf16 v[40:43], a[128:131], a[0:3], 0
    v_accvgpr_write_b32 a61, v90
    v_accvgpr_write_b32 a59, v86
    v_mfma_f32_16x16x32_bf16 v[40:43], a[132:135], a[4:7], v[40:43]
    v_cvt_pk_bf16_f32 v72, v72, v73
    v_cvt_pk_bf16_f32 v92, v92, v93
    v_mfma_f32_16x16x32_bf16 v[40:43], a[136:139], a[8:11], v[40:43]
    ds_read_b64_tr_b16 a[188:189], v2 offset:58120
    v_cvt_pk_bf16_f32 v94, v94, v95
    v_mfma_f32_16x16x32_bf16 v[40:43], a[140:143], a[12:15], v[40:43]
    buffer_store_dwordx4 a[104:107], v3, s[16:19], s33 offen offset:0 nt
    v_mfma_f32_16x16x32_bf16 v[44:47], a[140:143], a[28:31], 0
    v_accvgpr_write_b32 a62, v92
    v_accvgpr_write_b32 a63, v94
    v_mfma_f32_16x16x32_bf16 v[44:47], a[136:139], a[24:27], v[44:47]
    v_cvt_pk_bf16_f32 v74, v74, v75
    v_cvt_pk_bf16_f32 v76, v76, v77
    v_mfma_f32_16x16x32_bf16 v[44:47], a[132:135], a[20:23], v[44:47]
    ds_read_b64_tr_b16 a[190:191], v2 offset:62216
    v_cvt_pk_bf16_f32 v78, v78, v79
    v_mfma_f32_16x16x32_bf16 v[44:47], a[128:131], a[16:19], v[44:47]
    v_accvgpr_write_b32 a52, v72
    v_accvgpr_write_b32 a53, v74
    v_mfma_f32_16x16x32_bf16 v[48:51], a[128:131], a[32:35], 0
    v_accvgpr_write_b32 a54, v76
    v_accvgpr_write_b32 a55, v78
    v_mfma_f32_16x16x32_bf16 v[48:51], a[132:135], a[36:39], v[48:51]
    v_cvt_pk_bf16_f32 v64, v64, v65
    v_cvt_pk_bf16_f32 v66, v66, v67
    v_mfma_f32_16x16x32_bf16 v[48:51], a[136:139], a[40:43], v[48:51]
    ds_read_b128 a[144:147], v1 offset:4096
    v_cvt_pk_bf16_f32 v68, v68, v69
    v_mfma_f32_16x16x32_bf16 v[48:51], a[140:143], a[44:47], v[48:51]
    v_cvt_pk_bf16_f32 v70, v70, v71
    v_accvgpr_write_b32 a48, v64
    v_mfma_f32_16x16x32_bf16 v[56:59], a[140:143], a[60:63], 0
    v_accvgpr_write_b32 a49, v66
    v_accvgpr_write_b32 a50, v68
    v_mfma_f32_16x16x32_bf16 v[56:59], a[136:139], a[56:59], v[56:59]
    v_accvgpr_write_b32 a51, v70
    v_max3_f32 v21, v40, v41, v42
    v_mfma_f32_16x16x32_bf16 v[56:59], a[132:135], a[52:55], v[56:59]
    s_waitcnt lgkmcnt(1)
    ds_read_b128 a[148:151], v1 offset:4352
    v_max3_f32 v25, v44, v45, v46
    v_mfma_f32_16x16x32_bf16 v[56:59], a[128:131], a[48:51], v[56:59]
    buffer_load_dwordx4 v5, s[24:27], s41 offen offset:3072 nt lds
    v_mfma_f32_16x16x32_bf16 v[224:227], a[176:179], v[96:99], v[224:227]
    s_cselect_b32 s22, s22, 0
    v_max3_f32 v29, v48, v49, v50
    v_max_f32 v21, v21, v43
    v_mfma_f32_16x16x32_bf16 v[224:227], a[180:183], v[112:115], v[224:227]
    s_cselect_b32 s26, s26, 0
    v_max_f32 v25, v25, v47
    v_max3_f32 v33, v56, v57, v58
    v_mfma_f32_16x16x32_bf16 v[228:231], a[180:183], v[116:119], v[228:231]
    ds_read_b128 a[152:155], v1 offset:4608
    v_max_f32 v29, v29, v51
    v_mfma_f32_16x16x32_bf16 v[228:231], a[176:179], v[100:103], v[228:231]
    buffer_store_dwordx4 a[108:111], v3, s[16:19], s33 offen offset:2048 nt
    v_mfma_f32_16x16x32_bf16 v[232:235], a[176:179], v[104:107], v[232:235]
    v_max_f32 v33, v33, v59
    v_mul_f32 v224, v224, v14
    v_mfma_f32_16x16x32_bf16 v[232:235], a[180:183], v[120:123], v[232:235]
    v_permlane16_swap_b32 v21, v25
    v_mfma_f32_16x16x32_bf16 v[236:239], a[180:183], v[124:127], v[236:239]
    ds_read_b128 a[156:159], v1 offset:4864
    v_max_f32 v21, v21, v25
    v_mfma_f32_16x16x32_bf16 v[236:239], a[176:179], v[108:111], v[236:239]
    v_permlane16_swap_b32 v29, v33
    v_mfma_f32_16x16x32_bf16 v[240:243], a[184:187], v[96:99], v[240:243]
    v_max_f32 v29, v29, v33
    v_mul_f32 v225, v225, v14
    v_mfma_f32_16x16x32_bf16 v[240:243], a[188:191], v[112:115], v[240:243]
    v_permlane32_swap_b32 v21, v29
    v_max_f32 v21, v21, v29
    v_sub_f32 v20, v10, v21
    v_mov_b32 v28, v20
    v_mul_f32 v226, v226, v14
    v_mul_f32 v227, v227, v14
    v_permlane32_swap_b32 v20, v28
    v_mov_b32 v24, v20
    v_mul_f32 v240, v240, v14
    v_mul_f32 v241, v241, v14
    v_permlane16_swap_b32 v20, v24
    v_add_f32 v40, v40, v20
    v_add_f32 v41, v41, v20
    v_add_f32 v42, v42, v20
    v_add_f32 v43, v43, v20
    v_exp_f32 v40, v40
    v_exp_f32 v41, v41
    v_exp_f32 v42, v42
    v_exp_f32 v43, v43
    v_mov_b32 v21, v20
    v_mov_b32 v22, v20
    v_mov_b32 v23, v20
    v_cvt_pk_bf16_f32 v64, v40, v41
    v_cvt_pk_bf16_f32 v65, v42, v43
    v_add_f32 v44, v44, v24
    v_add_f32 v45, v45, v24
    v_add_f32 v46, v46, v24
    v_add_f32 v47, v47, v24
    v_exp_f32 v44, v44
    v_exp_f32 v45, v45
    v_exp_f32 v46, v46
    v_exp_f32 v47, v47
    v_mov_b32 v25, v24
    v_mov_b32 v26, v24
    v_mov_b32 v27, v24
    v_cvt_pk_bf16_f32 v68, v44, v45
    v_cvt_pk_bf16_f32 v69, v46, v47
    v_mul_f32 v242, v242, v14
    v_mul_f32 v243, v243, v14
    v_cvt_pk_bf16_f32 v224, v224, v225
    v_cvt_pk_bf16_f32 v225, v226, v227
    v_mov_b32 v32, v28
    v_cvt_pk_bf16_f32 v226, v240, v241
    v_cvt_pk_bf16_f32 v227, v242, v243
    v_permlane16_swap_b32 v28, v32
    v_mov_b32 v29, v28
    v_mov_b32 v30, v28
    v_mov_b32 v31, v28
    v_mul_f32 v228, v228, v15
    v_mul_f32 v229, v229, v15
    v_mul_f32 v230, v230, v15
    v_mfma_f32_16x16x32_bf16 v[244:247], a[188:191], v[116:119], v[244:247]
    s_waitcnt lgkmcnt(0)
    ds_read_b128 a[128:131], v1 offset:8192
    v_mul_f32 v231, v231, v15
    v_mfma_f32_16x16x32_bf16 v[244:247], a[184:187], v[100:103], v[244:247]
    ds_write_b128 v13, v[224:227] offset:0
    v_mov_b32 v33, v32
    v_mfma_f32_16x16x32_bf16 v[248:251], a[184:187], v[104:107], v[248:251]
    v_mov_b32 v34, v32
    v_mov_b32 v35, v32
    v_mfma_f32_16x16x32_bf16 v[248:251], a[188:191], v[120:123], v[248:251]
    v_cvt_pk_bf16_f32 v228, v228, v229
    v_cvt_pk_bf16_f32 v229, v230, v231
    v_mul_f32 v244, v244, v15
    v_mul_f32 v245, v245, v15
    v_mul_f32 v246, v246, v15
    v_mfma_f32_16x16x32_bf16 v[252:255], a[188:191], v[124:127], v[252:255]
    ds_read_b128 a[132:135], v1 offset:8448
    v_mul_f32 v247, v247, v15
    v_mfma_f32_16x16x32_bf16 v[252:255], a[184:187], v[108:111], v[252:255]
    buffer_store_dwordx4 a[112:115], v4, s[16:19], s32 offen offset:0 nt
    v_cvt_pk_bf16_f32 v230, v244, v245
    v_cvt_pk_bf16_f32 v231, v246, v247
    v_mul_f32 v232, v232, v16
    v_mfma_f32_16x16x32_bf16 v[40:43], a[144:147], a[0:3], v[20:23]
    ds_read_b128 a[212:215], v11 offset:0
    v_mul_f32 v233, v233, v16
    v_mfma_f32_16x16x32_bf16 v[40:43], a[148:151], a[4:7], v[40:43]
    v_mul_f32 v234, v234, v16
    v_mul_f32 v235, v235, v16
    v_mfma_f32_16x16x32_bf16 v[40:43], a[152:155], a[8:11], v[40:43]
    ds_read_b128 a[136:139], v1 offset:8704
    v_mul_f32 v248, v248, v16
    v_mfma_f32_16x16x32_bf16 v[40:43], a[156:159], a[12:15], v[40:43]
    ds_write_b128 v13, v[228:231] offset:2048
    v_mul_f32 v249, v249, v16
    v_mul_f32 v250, v250, v16
    v_mul_f32 v251, v251, v16
    v_cvt_pk_bf16_f32 v232, v232, v233
    v_mfma_f32_16x16x32_bf16 v[44:47], a[156:159], a[28:31], v[24:27]
    ds_read_b128 a[216:219], v11 offset:1024
    v_cvt_pk_bf16_f32 v233, v234, v235
    v_mfma_f32_16x16x32_bf16 v[44:47], a[152:155], a[24:27], v[44:47]
    v_exp_f32 v40, v40
    v_mfma_f32_16x16x32_bf16 v[44:47], a[148:151], a[20:23], v[44:47]
    ds_read_b128 a[140:143], v1 offset:8960
    v_cvt_pk_bf16_f32 v234, v248, v249
    v_mfma_f32_16x16x32_bf16 v[44:47], a[144:147], a[16:19], v[44:47]
    v_exp_f32 v41, v41
    v_exp_f32 v42, v42
    v_exp_f32 v43, v43
    v_cvt_pk_bf16_f32 v66, v40, v41
    v_cvt_pk_bf16_f32 v67, v42, v43
    v_mfma_f32_16x16x32_bf16 v[52:55], a[144:147], a[32:35], v[28:31]
    ds_read_b128 a[220:223], v11 offset:2048
    v_cvt_pk_bf16_f32 v235, v250, v251
    v_mfma_f32_16x16x32_bf16 v[52:55], a[148:151], a[36:39], v[52:55]
    ds_read_b128 a[224:227], v11 offset:3072
    v_mul_f32 v236, v236, v17
    v_mfma_f32_16x16x32_bf16 v[52:55], a[152:155], a[40:43], v[52:55]
    v_mul_f32 v237, v237, v17
    v_mul_f32 v238, v238, v17
    v_mfma_f32_16x16x32_bf16 v[52:55], a[156:159], a[44:47], v[52:55]
    ds_write_b128 v13, v[232:235] offset:4096
    v_exp_f32 v44, v44
    v_exp_f32 v45, v45
    v_mfma_f32_16x16x32_bf16 v[60:63], a[156:159], a[60:63], v[32:35]
    s_waitcnt lgkmcnt(3)
    ds_read_b128 a[228:231], v11 offset:4096
    v_cvt_pk_bf16_f32 v70, v44, v45
    v_mfma_f32_16x16x32_bf16 v[60:63], a[152:155], a[56:59], v[60:63]
    v_exp_f32 v46, v46
    v_mfma_f32_16x16x32_bf16 v[60:63], a[148:151], a[52:55], v[60:63]
    ds_read_b128 a[148:151], v1 offset:12544
    v_mul_f32 v239, v239, v17
    v_mfma_f32_16x16x32_bf16 v[60:63], a[144:147], a[48:51], v[60:63]
    buffer_store_dwordx4 a[116:119], v4, s[16:19], s32 offen offset:2048 nt
    v_exp_f32 v47, v47
    v_cvt_pk_bf16_f32 v236, v236, v237
    v_mfma_f32_16x16x32_bf16 v[40:43], a[128:131], a[0:3], v[20:23]
    s_mov_b64 s[32:33], s[30:31]
    ds_read_b128 a[144:147], v1 offset:12288
    v_cvt_pk_bf16_f32 v71, v46, v47
    v_mfma_f32_16x16x32_bf16 v[40:43], a[132:135], a[4:7], v[40:43]
    s_add_u32 s30, s30, s42
    ds_read_b128 a[232:235], v11 offset:5120
    v_mul_f32 v252, v252, v17
    v_mfma_f32_16x16x32_bf16 v[40:43], a[136:139], a[8:11], v[40:43]
    s_add_u32 s31, s31, s42
    ds_read_b128 a[152:155], v1 offset:12800
    v_mul_f32 v253, v253, v17
    v_mfma_f32_16x16x32_bf16 v[40:43], a[140:143], a[12:15], v[40:43]
    s_add_u32 s64, s64, s42
    v_mul_f32 v254, v254, v17
    v_mul_f32 v255, v255, v17
    v_cvt_pk_bf16_f32 v237, v238, v239
    v_cvt_pk_bf16_f32 v238, v252, v253
    v_cvt_pk_bf16_f32 v239, v254, v255
    v_add_f32 v48, v48, v28
    v_add_f32 v49, v49, v28
    v_add_f32 v50, v50, v28
    v_add_f32 v51, v51, v28
    v_mfma_f32_16x16x32_bf16 v[44:47], a[140:143], a[28:31], v[24:27]
    s_add_u32 s65, s65, s42
    v_exp_f32 v48, v48
    v_mfma_f32_16x16x32_bf16 v[44:47], a[136:139], a[24:27], v[44:47]
    s_add_u32 s29, s29, s45
    v_exp_f32 v49, v49
    v_mfma_f32_16x16x32_bf16 v[44:47], a[132:135], a[20:23], v[44:47]
    ds_read_b128 a[156:159], v1 offset:13056
    v_cvt_pk_bf16_f32 v72, v48, v49
    v_mfma_f32_16x16x32_bf16 v[44:47], a[128:131], a[16:19], v[44:47]
    ds_write_b128 v13, v[236:239] offset:6144
    v_exp_f32 v50, v50
    v_exp_f32 v51, v51
    v_add_f32 v56, v56, v32
    v_cvt_pk_bf16_f32 v73, v50, v51
    v_mfma_f32_16x16x32_bf16 v[48:51], a[128:131], a[32:35], v[28:31]
    ds_read_b128 a[236:239], v11 offset:6144
    v_add_f32 v57, v57, v32
    v_mfma_f32_16x16x32_bf16 v[48:51], a[132:135], a[36:39], v[48:51]
    ds_read_b128 a[240:243], v11 offset:7168
    v_add_f32 v58, v58, v32
    v_mfma_f32_16x16x32_bf16 v[48:51], a[136:139], a[40:43], v[48:51]
    v_add_f32 v59, v59, v32
    v_mfma_f32_16x16x32_bf16 v[48:51], a[140:143], a[44:47], v[48:51]
    v_exp_f32 v56, v56
    v_exp_f32 v57, v57
    v_exp_f32 v58, v58
    v_exp_f32 v59, v59
    v_cvt_pk_bf16_f32 v76, v56, v57
    v_cvt_pk_bf16_f32 v77, v58, v59
    v_mfma_f32_16x16x32_bf16 v[56:59], a[140:143], a[60:63], v[32:35]
    s_waitcnt lgkmcnt(3)
    v_exp_f32 v40, v40
    v_mfma_f32_16x16x32_bf16 v[56:59], a[136:139], a[56:59], v[56:59]
    s_waitcnt vmcnt(25)
    v_exp_f32 v41, v41
    v_mfma_f32_16x16x32_bf16 v[56:59], a[132:135], a[52:55], v[56:59]
    v_exp_f32 v42, v42
    v_mfma_f32_16x16x32_bf16 v[56:59], a[128:131], a[48:51], v[56:59]
    s_barrier
    v_exp_f32 v43, v43
    v_cvt_pk_bf16_f32 v80, v40, v41
    v_cvt_pk_bf16_f32 v81, v42, v43
    v_mfma_f32_16x16x32_bf16 v[40:43], a[144:147], a[0:3], v[20:23]
    ds_read_b128 a[128:131], v1 offset:16384
    s_nop 0
    v_mfma_f32_16x16x32_bf16 v[40:43], a[148:151], a[4:7], v[40:43]
    v_exp_f32 v44, v44
    v_mfma_f32_16x16x32_bf16 v[40:43], a[152:155], a[8:11], v[40:43]
    v_exp_f32 v45, v45
    v_mfma_f32_16x16x32_bf16 v[40:43], a[156:159], a[12:15], v[40:43]
    v_exp_f32 v46, v46
    v_exp_f32 v47, v47
    v_cvt_pk_bf16_f32 v84, v44, v45
    v_cvt_pk_bf16_f32 v85, v46, v47
    v_exp_f32 v52, v52
    v_exp_f32 v53, v53
    v_mfma_f32_16x16x32_bf16 v[44:47], a[156:159], a[28:31], v[24:27]
    ds_read_b128 a[132:135], v1 offset:16640
    v_cvt_pk_bf16_f32 v74, v52, v53
    v_mfma_f32_16x16x32_bf16 v[44:47], a[152:155], a[24:27], v[44:47]
    v_exp_f32 v54, v54
    v_mfma_f32_16x16x32_bf16 v[44:47], a[148:151], a[20:23], v[44:47]
    v_exp_f32 v55, v55
    v_mfma_f32_16x16x32_bf16 v[44:47], a[144:147], a[16:19], v[44:47]
    ds_read_b128 a[136:139], v1 offset:16896
    v_cvt_pk_bf16_f32 v75, v54, v55
    v_exp_f32 v60, v60
    v_exp_f32 v61, v61
    v_exp_f32 v62, v62
    v_exp_f32 v63, v63
    v_mfma_f32_16x16x32_bf16 v[52:55], a[144:147], a[32:35], v[28:31]
    v_cvt_pk_bf16_f32 v78, v60, v61
    v_cvt_pk_bf16_f32 v79, v62, v63
    v_mfma_f32_16x16x32_bf16 v[52:55], a[148:151], a[36:39], v[52:55]
    v_exp_f32 v48, v48
    v_mfma_f32_16x16x32_bf16 v[52:55], a[152:155], a[40:43], v[52:55]
    ds_read_b128 a[140:143], v1 offset:17152
    v_mfma_f32_16x16x32_bf16 v[52:55], a[156:159], a[44:47], v[52:55]
    v_exp_f32 v49, v49
    v_exp_f32 v50, v50
    v_exp_f32 v51, v51
    v_mfma_f32_16x16x32_bf16 v[60:63], a[156:159], a[60:63], v[32:35]
    v_exp_f32 v56, v56
    v_mfma_f32_16x16x32_bf16 v[60:63], a[152:155], a[56:59], v[60:63]
    v_exp_f32 v57, v57
    v_mfma_f32_16x16x32_bf16 v[60:63], a[148:151], a[52:55], v[60:63]
    v_exp_f32 v58, v58
    v_mfma_f32_16x16x32_bf16 v[60:63], a[144:147], a[48:51], v[60:63]
    v_exp_f32 v59, v59
    v_cvt_pk_bf16_f32 v88, v48, v49
    v_cvt_pk_bf16_f32 v89, v50, v51
    v_cvt_pk_bf16_f32 v92, v56, v57
    v_cvt_pk_bf16_f32 v93, v58, v59
    s_branch L_next
L_final:
    v_mfma_f32_16x16x32_bf16 a[192:195], a[208:211], v[96:99], a[192:195]
    s_waitcnt lgkmcnt(0)
    ds_read_b64_tr_b16 a[176:177], v2 offset:49408
    ds_read_b64_tr_b16 a[178:179], v2 offset:53504
    v_mfma_f32_16x16x32_bf16 a[192:195], a[208:211], v[112:115], a[192:195]
    ds_read_b64_tr_b16 a[180:181], v2 offset:57600
    ds_read_b64_tr_b16 a[182:183], v2 offset:61696
    v_bfe_u32 v66, v0, 4, 2
    v_mfma_f32_16x16x32_bf16 v[128:131], a[160:163], v[96:99], v[128:131]
    ds_read_b64_tr_b16 a[184:185], v2 offset:49416
    ds_read_b64_tr_b16 a[186:187], v2 offset:53512
    v_mfma_f32_16x16x32_bf16 v[128:131], a[164:167], v[112:115], v[128:131]
    ds_read_b64_tr_b16 a[188:189], v2 offset:57608
    ds_read_b64_tr_b16 a[190:191], v2 offset:61704
    v_accvgpr_read_b32 v14, a192
    v_cmp_nge_f32 s[48:49], s36, v14
    v_rcp_f32 v14, v14
    v_mfma_f32_16x16x32_bf16 v[144:147], a[168:171], v[96:99], v[144:147]
    s_waitcnt vmcnt(12)
    ds_read_b64_tr_b16 a[128:129], v2 offset:49664
    ds_read_b64_tr_b16 a[130:131], v2 offset:53760
    v_mfma_f32_16x16x32_bf16 v[144:147], a[172:175], v[112:115], v[144:147]
    s_waitcnt lgkmcnt(2)
    ds_read_b64_tr_b16 a[132:133], v2 offset:57856
    ds_read_b64_tr_b16 a[134:135], v2 offset:61952
    v_mul_f32 v128, v128, v14
    v_mul_f32 v129, v129, v14
    v_mul_f32 v130, v130, v14
    v_and_b32 v71, 7, v0
    v_mul_f32 v131, v131, v14
    v_and_b32 v65, 15, v0
    v_xor_b32 v71, v71, v66
    v_mul_f32 v144, v144, v14
    v_lshlrev_b32 v71, 4, v71
    v_xor_b32 v64, v65, v66
    v_mul_f32 v145, v145, v14
    v_lshl_add_u32 v71, v65, 8, v71
    v_lshlrev_b32 v64, 4, v64
    v_add_u32 v67, s66, v71
    v_lshl_add_u32 v69, v66, 8, v64
    v_mul_f32 v146, v146, v14
    v_xor_b32 v68, 64, v67
    v_xor_b32 v70, 64, v69
    v_mfma_f32_16x16x32_bf16 v[160:163], a[176:179], v[96:99], v[160:163]
    ds_read_b64_tr_b16 a[136:137], v2 offset:49672
    ds_read_b64_tr_b16 a[138:139], v2 offset:53768
    v_mfma_f32_16x16x32_bf16 v[160:163], a[180:183], v[112:115], v[160:163]
    ds_read_b64_tr_b16 a[140:141], v2 offset:57864
    ds_read_b64_tr_b16 a[142:143], v2 offset:61960
    v_mfma_f32_16x16x32_bf16 v[176:179], a[184:187], v[96:99], v[176:179]
    ds_read_b64_tr_b16 a[144:145], v2 offset:49920
    ds_read_b64_tr_b16 a[146:147], v2 offset:54016
    v_mfma_f32_16x16x32_bf16 v[176:179], a[188:191], v[112:115], v[176:179]
    s_waitcnt lgkmcnt(2)
    ds_read_b64_tr_b16 a[148:149], v2 offset:58112
    ds_read_b64_tr_b16 a[150:151], v2 offset:62208
    v_mul_f32 v147, v147, v14
    v_cvt_pk_bf16_f32 v128, v128, v129
    v_cvt_pk_bf16_f32 v129, v130, v131
    v_cvt_pk_bf16_f32 v130, v144, v145
    v_cvt_pk_bf16_f32 v131, v146, v147
    v_mul_f32 v160, v160, v14
    v_mul_f32 v161, v161, v14
    v_mul_f32 v162, v162, v14
    v_mul_f32 v163, v163, v14
    v_mul_f32 v176, v176, v14
    v_mul_f32 v177, v177, v14
    v_mul_f32 v178, v178, v14
    v_mfma_f32_16x16x32_bf16 v[192:195], a[128:131], v[96:99], v[192:195]
    ds_read_b64_tr_b16 a[152:153], v2 offset:49928
    ds_read_b64_tr_b16 a[154:155], v2 offset:54024
    v_mfma_f32_16x16x32_bf16 v[192:195], a[132:135], v[112:115], v[192:195]
    ds_write_b128 v67, v[128:131] offset:0
    v_mfma_f32_16x16x32_bf16 v[208:211], a[136:139], v[96:99], v[208:211]
    ds_read_b64_tr_b16 a[156:157], v2 offset:58120
    ds_read_b64_tr_b16 a[158:159], v2 offset:62216
    v_mfma_f32_16x16x32_bf16 v[208:211], a[140:143], v[112:115], v[208:211]
    s_waitcnt lgkmcnt(0)
    v_mul_f32 v179, v179, v14
    v_cvt_pk_bf16_f32 v160, v160, v161
    v_cvt_pk_bf16_f32 v161, v162, v163
    v_cvt_pk_bf16_f32 v162, v176, v177
    v_cvt_pk_bf16_f32 v163, v178, v179
    v_mul_f32 v192, v192, v14
    v_mul_f32 v193, v193, v14
    v_mul_f32 v194, v194, v14
    v_mul_f32 v195, v195, v14
    v_mul_f32 v208, v208, v14
    v_mul_f32 v209, v209, v14
    v_mul_f32 v210, v210, v14
    v_mfma_f32_16x16x32_bf16 v[224:227], a[144:147], v[96:99], v[224:227]
    v_mul_f32 v211, v211, v14
    v_cvt_pk_bf16_f32 v192, v192, v193
    v_mfma_f32_16x16x32_bf16 v[224:227], a[148:151], v[112:115], v[224:227]
    ds_write_b128 v68, v[160:163] offset:0
    v_mfma_f32_16x16x32_bf16 v[240:243], a[152:155], v[96:99], v[240:243]
    v_exp_f32 v60, v60
    v_mfma_f32_16x16x32_bf16 v[240:243], a[156:159], v[112:115], v[240:243]
    v_cvt_pk_bf16_f32 v193, v194, v195
    v_cvt_pk_bf16_f32 v194, v208, v209
    v_mfma_f32_16x16x32_bf16 a[196:199], a[208:211], v[100:103], a[196:199]
    v_cvt_pk_bf16_f32 v195, v210, v211
    v_mul_f32 v224, v224, v14
    v_mfma_f32_16x16x32_bf16 a[196:199], a[208:211], v[116:119], a[196:199]
    ds_write_b128 v67, v[192:195] offset:128
    v_mfma_f32_16x16x32_bf16 v[132:135], a[160:163], v[100:103], v[132:135]
    v_mul_f32 v225, v225, v14
    v_mul_f32 v226, v226, v14
    v_mfma_f32_16x16x32_bf16 v[132:135], a[164:167], v[116:119], v[132:135]
    v_mul_f32 v227, v227, v14
    v_cvt_pk_bf16_f32 v224, v224, v225
    v_mul_f32 v240, v240, v14
    v_mul_f32 v241, v241, v14
    v_mfma_f32_16x16x32_bf16 v[148:151], a[168:171], v[100:103], v[148:151]
    v_mul_f32 v242, v242, v14
    v_mul_f32 v243, v243, v14
    v_mfma_f32_16x16x32_bf16 v[148:151], a[172:175], v[116:119], v[148:151]
    v_cvt_pk_bf16_f32 v225, v226, v227
    v_cvt_pk_bf16_f32 v226, v240, v241
    v_mfma_f32_16x16x32_bf16 v[164:167], a[176:179], v[100:103], v[164:167]
    v_cvt_pk_bf16_f32 v227, v242, v243
    v_accvgpr_read_b32 v15, a196
    v_mfma_f32_16x16x32_bf16 v[164:167], a[180:183], v[116:119], v[164:167]
    ds_write_b128 v68, v[224:227] offset:128
    v_mfma_f32_16x16x32_bf16 v[180:183], a[184:187], v[100:103], v[180:183]
    ds_read_b128 a[96:99], v11 offset:0
    ds_read_b128 a[100:103], v11 offset:1024
    v_mfma_f32_16x16x32_bf16 v[180:183], a[188:191], v[116:119], v[180:183]
    ds_read_b128 a[104:107], v11 offset:2048
    ds_read_b128 a[108:111], v11 offset:3072
    v_mfma_f32_16x16x32_bf16 v[196:199], a[128:131], v[100:103], v[196:199]
    s_waitcnt lgkmcnt(0)
    v_cmp_nge_f32 s[50:51], s36, v15
    v_mfma_f32_16x16x32_bf16 v[196:199], a[132:135], v[116:119], v[196:199]
    buffer_store_dwordx4 a[96:99], v69, s[16:19], s32 offen offset:0 nt
    v_mfma_f32_16x16x32_bf16 v[212:215], a[136:139], v[100:103], v[212:215]
    v_rcp_f32 v15, v15
    v_mfma_f32_16x16x32_bf16 v[212:215], a[140:143], v[116:119], v[212:215]
    v_mul_f32 v132, v132, v15
    v_mul_f32 v133, v133, v15
    v_mul_f32 v134, v134, v15
    v_mul_f32 v135, v135, v15
    v_mul_f32 v148, v148, v15
    v_mul_f32 v149, v149, v15
    v_mul_f32 v150, v150, v15
    v_mul_f32 v151, v151, v15
    v_cvt_pk_bf16_f32 v132, v132, v133
    v_cvt_pk_bf16_f32 v133, v134, v135
    v_cvt_pk_bf16_f32 v134, v148, v149
    v_cvt_pk_bf16_f32 v135, v150, v151
    v_mul_f32 v164, v164, v15
    v_mul_f32 v165, v165, v15
    v_mul_f32 v166, v166, v15
    v_mul_f32 v167, v167, v15
    v_mul_f32 v180, v180, v15
    v_mul_f32 v181, v181, v15
    v_mul_f32 v182, v182, v15
    v_mul_f32 v183, v183, v15
    v_cvt_pk_bf16_f32 v164, v164, v165
    v_cvt_pk_bf16_f32 v165, v166, v167
    v_cvt_pk_bf16_f32 v166, v180, v181
    v_cvt_pk_bf16_f32 v167, v182, v183
    v_mul_f32 v196, v196, v15
    v_mul_f32 v197, v197, v15
    v_mul_f32 v198, v198, v15
    v_mul_f32 v199, v199, v15
    v_mul_f32 v212, v212, v15
    v_mfma_f32_16x16x32_bf16 v[228:231], a[144:147], v[100:103], v[228:231]
    v_mul_f32 v213, v213, v15
    v_mul_f32 v214, v214, v15
    v_mfma_f32_16x16x32_bf16 v[228:231], a[148:151], v[116:119], v[228:231]
    ds_write_b128 v67, v[132:135] offset:4096
    v_mfma_f32_16x16x32_bf16 v[244:247], a[152:155], v[100:103], v[244:247]
    v_mul_f32 v215, v215, v15
    v_cvt_pk_bf16_f32 v196, v196, v197
    v_mfma_f32_16x16x32_bf16 v[244:247], a[156:159], v[116:119], v[244:247]
    buffer_store_dwordx4 a[100:103], v70, s[16:19], s32 offen offset:1024 nt
    v_mfma_f32_16x16x32_bf16 a[200:203], a[208:211], v[104:107], a[200:203]
    v_cvt_pk_bf16_f32 v197, v198, v199
    v_cvt_pk_bf16_f32 v198, v212, v213
    v_mfma_f32_16x16x32_bf16 a[200:203], a[208:211], v[120:123], a[200:203]
    ds_write_b128 v68, v[164:167] offset:4096
    v_cvt_pk_bf16_f32 v199, v214, v215
    v_mfma_f32_16x16x32_bf16 v[136:139], a[160:163], v[104:107], v[136:139]
    v_mul_f32 v228, v228, v15
    v_mul_f32 v229, v229, v15
    v_mfma_f32_16x16x32_bf16 v[136:139], a[164:167], v[120:123], v[136:139]
    ds_write_b128 v67, v[196:199] offset:4224
    v_mul_f32 v230, v230, v15
    v_mul_f32 v231, v231, v15
    v_cvt_pk_bf16_f32 v228, v228, v229
    v_mul_f32 v244, v244, v15
    v_mul_f32 v245, v245, v15
    v_mfma_f32_16x16x32_bf16 v[152:155], a[168:171], v[104:107], v[152:155]
    v_mul_f32 v246, v246, v15
    v_mul_f32 v247, v247, v15
    v_mfma_f32_16x16x32_bf16 v[152:155], a[172:175], v[120:123], v[152:155]
    buffer_store_dwordx4 a[104:107], v69, s[16:19], s32 offen offset:2048 nt
    v_mfma_f32_16x16x32_bf16 v[168:171], a[176:179], v[104:107], v[168:171]
    v_cvt_pk_bf16_f32 v229, v230, v231
    v_cvt_pk_bf16_f32 v230, v244, v245
    v_mfma_f32_16x16x32_bf16 v[168:171], a[180:183], v[120:123], v[168:171]
    buffer_store_dwordx4 a[108:111], v70, s[16:19], s32 offen offset:3072 nt
    v_mfma_f32_16x16x32_bf16 v[184:187], a[184:187], v[104:107], v[184:187]
    v_cvt_pk_bf16_f32 v231, v246, v247
    v_accvgpr_read_b32 v16, a200
    v_mfma_f32_16x16x32_bf16 v[184:187], a[188:191], v[120:123], v[184:187]
    ds_write_b128 v68, v[228:231] offset:4224
    v_mfma_f32_16x16x32_bf16 v[200:203], a[128:131], v[104:107], v[200:203]
    ds_read_b128 a[112:115], v11 offset:4096
    ds_read_b128 a[116:119], v11 offset:5120
    v_mfma_f32_16x16x32_bf16 v[200:203], a[132:135], v[120:123], v[200:203]
    ds_read_b128 a[120:123], v11 offset:6144
    ds_read_b128 a[124:127], v11 offset:7168
    v_mfma_f32_16x16x32_bf16 v[216:219], a[136:139], v[104:107], v[216:219]
    s_waitcnt lgkmcnt(0)
    v_cmp_nge_f32 s[52:53], s36, v16
    v_mfma_f32_16x16x32_bf16 v[216:219], a[140:143], v[120:123], v[216:219]
    buffer_store_dwordx4 a[112:115], v69, s[16:19], s33 offen offset:0 nt
    v_mfma_f32_16x16x32_bf16 v[232:235], a[144:147], v[104:107], v[232:235]
    v_rcp_f32 v16, v16
    v_mfma_f32_16x16x32_bf16 v[232:235], a[148:151], v[120:123], v[232:235]
    buffer_store_dwordx4 a[116:119], v70, s[16:19], s33 offen offset:1024 nt
    v_mul_f32 v136, v136, v16
    v_mul_f32 v137, v137, v16
    v_mul_f32 v138, v138, v16
    v_mul_f32 v139, v139, v16
    v_mul_f32 v152, v152, v16
    v_mul_f32 v153, v153, v16
    v_mul_f32 v154, v154, v16
    v_mul_f32 v155, v155, v16
    v_cvt_pk_bf16_f32 v136, v136, v137
    v_cvt_pk_bf16_f32 v137, v138, v139
    v_cvt_pk_bf16_f32 v138, v152, v153
    v_cvt_pk_bf16_f32 v139, v154, v155
    v_mul_f32 v168, v168, v16
    v_mul_f32 v169, v169, v16
    v_mul_f32 v170, v170, v16
    v_mul_f32 v171, v171, v16
    v_mul_f32 v184, v184, v16
    v_mul_f32 v185, v185, v16
    v_mul_f32 v186, v186, v16
    v_mul_f32 v187, v187, v16
    v_cvt_pk_bf16_f32 v168, v168, v169
    v_cvt_pk_bf16_f32 v169, v170, v171
    v_cvt_pk_bf16_f32 v170, v184, v185
    v_cvt_pk_bf16_f32 v171, v186, v187
    v_mul_f32 v200, v200, v16
    v_mul_f32 v201, v201, v16
    v_mul_f32 v202, v202, v16
    v_mul_f32 v203, v203, v16
    v_mul_f32 v216, v216, v16
    v_mul_f32 v217, v217, v16
    v_mul_f32 v218, v218, v16
    v_mul_f32 v219, v219, v16
    v_cvt_pk_bf16_f32 v200, v200, v201
    v_cvt_pk_bf16_f32 v201, v202, v203
    v_cvt_pk_bf16_f32 v202, v216, v217
    v_cvt_pk_bf16_f32 v203, v218, v219
    v_mfma_f32_16x16x32_bf16 v[248:251], a[152:155], v[104:107], v[248:251]
    ds_write_b128 v67, v[136:139] offset:0
    v_mfma_f32_16x16x32_bf16 v[248:251], a[156:159], v[120:123], v[248:251]
    ds_write_b128 v68, v[168:171] offset:0
    v_mfma_f32_16x16x32_bf16 a[204:207], a[208:211], v[108:111], a[204:207]
    v_exp_f32 v61, v61
    v_exp_f32 v62, v62
    v_exp_f32 v63, v63
    v_cvt_pk_bf16_f32 v126, v60, v61
    v_cvt_pk_bf16_f32 v127, v62, v63
    v_mul_f32 v232, v232, v16
    v_mul_f32 v233, v233, v16
    v_mfma_f32_16x16x32_bf16 a[204:207], a[208:211], v[124:127], a[204:207]
    ds_write_b128 v67, v[200:203] offset:128
    v_mfma_f32_16x16x32_bf16 v[140:143], a[160:163], v[108:111], v[140:143]
    v_mul_f32 v234, v234, v16
    v_mul_f32 v235, v235, v16
    v_mfma_f32_16x16x32_bf16 v[140:143], a[164:167], v[124:127], v[140:143]
    buffer_store_dwordx4 a[120:123], v69, s[16:19], s33 offen offset:2048 nt
    v_mfma_f32_16x16x32_bf16 v[156:159], a[168:171], v[108:111], v[156:159]
    v_cvt_pk_bf16_f32 v232, v232, v233
    v_mul_f32 v248, v248, v16
    v_mfma_f32_16x16x32_bf16 v[156:159], a[172:175], v[124:127], v[156:159]
    buffer_store_dwordx4 a[124:127], v70, s[16:19], s33 offen offset:3072 nt
    v_mfma_f32_16x16x32_bf16 v[172:175], a[176:179], v[108:111], v[172:175]
    v_mul_f32 v249, v249, v16
    v_mul_f32 v250, v250, v16
    v_mfma_f32_16x16x32_bf16 v[172:175], a[180:183], v[124:127], v[172:175]
    v_mul_f32 v251, v251, v16
    v_cvt_pk_bf16_f32 v233, v234, v235
    v_mfma_f32_16x16x32_bf16 v[188:191], a[184:187], v[108:111], v[188:191]
    v_cvt_pk_bf16_f32 v234, v248, v249
    v_cvt_pk_bf16_f32 v235, v250, v251
    v_mfma_f32_16x16x32_bf16 v[188:191], a[188:191], v[124:127], v[188:191]
    ds_write_b128 v68, v[232:235] offset:128
    v_mfma_f32_16x16x32_bf16 v[204:207], a[128:131], v[108:111], v[204:207]
    ds_read_b128 a[212:215], v11 offset:0
    ds_read_b128 a[216:219], v11 offset:1024
    v_mfma_f32_16x16x32_bf16 v[204:207], a[132:135], v[124:127], v[204:207]
    ds_read_b128 a[220:223], v11 offset:2048
    ds_read_b128 a[224:227], v11 offset:3072
    v_mfma_f32_16x16x32_bf16 v[220:223], a[136:139], v[108:111], v[220:223]
    s_waitcnt lgkmcnt(0)
    v_add_u32 v69, s46, v69
    v_add_u32 v70, s46, v70
    v_mfma_f32_16x16x32_bf16 v[220:223], a[140:143], v[124:127], v[220:223]
    buffer_store_dwordx4 a[212:215], v69, s[16:19], s32 offen offset:0 nt
    v_mfma_f32_16x16x32_bf16 v[236:239], a[144:147], v[108:111], v[236:239]
    v_accvgpr_read_b32 v17, a204
    v_cmp_nge_f32 s[54:55], s36, v17
    v_mfma_f32_16x16x32_bf16 v[236:239], a[148:151], v[124:127], v[236:239]
    buffer_store_dwordx4 a[216:219], v70, s[16:19], s32 offen offset:1024 nt
    v_mfma_f32_16x16x32_bf16 v[252:255], a[152:155], v[108:111], v[252:255]
    v_rcp_f32 v17, v17
    v_mfma_f32_16x16x32_bf16 v[252:255], a[156:159], v[124:127], v[252:255]
    v_mul_f32 v140, v140, v17
    v_mul_f32 v141, v141, v17
    v_mul_f32 v142, v142, v17
    v_mul_f32 v143, v143, v17
    v_mul_f32 v156, v156, v17
    v_mul_f32 v157, v157, v17
    v_mul_f32 v158, v158, v17
    v_mul_f32 v159, v159, v17
    v_cvt_pk_bf16_f32 v140, v140, v141
    v_cvt_pk_bf16_f32 v141, v142, v143
    v_cvt_pk_bf16_f32 v142, v156, v157
    v_cvt_pk_bf16_f32 v143, v158, v159
    v_mul_f32 v172, v172, v17
    v_mul_f32 v173, v173, v17
    v_mul_f32 v174, v174, v17
    v_mul_f32 v175, v175, v17
    v_mul_f32 v188, v188, v17
    v_mul_f32 v189, v189, v17
    v_mul_f32 v190, v190, v17
    v_mul_f32 v191, v191, v17
    v_cvt_pk_bf16_f32 v172, v172, v173
    v_cvt_pk_bf16_f32 v173, v174, v175
    v_cvt_pk_bf16_f32 v174, v188, v189
    v_cvt_pk_bf16_f32 v175, v190, v191
    v_mul_f32 v204, v204, v17
    v_mul_f32 v205, v205, v17
    v_mul_f32 v206, v206, v17
    v_mul_f32 v207, v207, v17
    v_mul_f32 v220, v220, v17
    v_mul_f32 v221, v221, v17
    v_mul_f32 v222, v222, v17
    v_mul_f32 v223, v223, v17
    v_cvt_pk_bf16_f32 v204, v204, v205
    v_cvt_pk_bf16_f32 v205, v206, v207
    v_cvt_pk_bf16_f32 v206, v220, v221
    v_cvt_pk_bf16_f32 v207, v222, v223
    v_mul_f32 v236, v236, v17
    v_mul_f32 v237, v237, v17
    v_mul_f32 v238, v238, v17
    v_mul_f32 v239, v239, v17
    v_cvt_pk_bf16_f32 v236, v236, v237
    v_mul_f32 v252, v252, v17
    v_mul_f32 v253, v253, v17
    v_mul_f32 v254, v254, v17
    v_mul_f32 v255, v255, v17
    v_cvt_pk_bf16_f32 v237, v238, v239
    v_cvt_pk_bf16_f32 v238, v252, v253
    v_cvt_pk_bf16_f32 v239, v254, v255
    ds_write_b128 v67, v[140:143] offset:4096
    ds_write_b128 v68, v[172:175] offset:4096
    ds_write_b128 v67, v[204:207] offset:4224
    buffer_store_dwordx4 a[220:223], v69, s[16:19], s32 offen offset:2048 nt
    ds_write_b128 v68, v[236:239] offset:4224
    ds_read_b128 a[228:231], v11 offset:4096
    ds_read_b128 a[232:235], v11 offset:5120
    ds_read_b128 a[236:239], v11 offset:6144
    ds_read_b128 a[240:243], v11 offset:7168
    buffer_store_dwordx4 a[224:227], v70, s[16:19], s32 offen offset:3072 nt
    s_waitcnt lgkmcnt(0)
    buffer_store_dwordx4 a[228:231], v69, s[16:19], s33 offen offset:0 nt
    buffer_store_dwordx4 a[232:235], v70, s[16:19], s33 offen offset:1024 nt
    buffer_store_dwordx4 a[236:239], v69, s[16:19], s33 offen offset:2048 nt
    buffer_store_dwordx4 a[240:243], v70, s[16:19], s33 offen offset:3072 nt
    s_or_b64 s[48:49], s[48:49], s[50:51]
    s_or_b64 s[52:53], s[52:53], s[54:55]
    s_or_b64 s[48:49], s[48:49], s[52:53]
    s_cselect_b32 s42, 8, 0
    s_or_b32 s38, s38, s42
    s_cmp_eq_u32 s38, 0
    s_cbranch_scc1 L_end
    s_waitcnt vmcnt(0) lgkmcnt(0)
    s_mov_b32 s6, 65011712
    s_sub_u32 s42, s66, 65536
    v_add_u32 v38, s42, v2
    v_and_b32 v20, 15, v0
    v_bfe_u32 v21, v0, 4, 2
    v_lshlrev_b32 v20, 8, v20
    v_lshl_add_u32 v36, v21, 4, v20
    v_add_u32 v37, s46, v36
    s_mov_b32 s37, 0
L_slow_blk:
    s_lshr_b32 s42, s38, s37
    s_and_b32 s42, s42, 1
    s_cmp_eq_u32 s42, 0
    s_cbranch_scc1 L_slow_next
    s_mul_i32 s42, s37, 1
    s_add_u32 s56, s43, s42
    s_mul_i32 s42, s56, 253952
    s_lshl_b32 s45, s44, 16
    s_add_u32 s42, s42, s45
    s_lshl_b32 s45, s39, 2
    s_add_u32 s32, s42, s45
    s_add_u32 s33, s32, 4096
    buffer_load_dwordx4 a[0:3], v36, s[4:7], s32 offen offset:0
    buffer_load_dwordx4 a[4:7], v36, s[4:7], s32 offen offset:64
    buffer_load_dwordx4 a[8:11], v36, s[4:7], s32 offen offset:128
    buffer_load_dwordx4 a[12:15], v36, s[4:7], s32 offen offset:192
    buffer_load_dwordx4 a[16:19], v36, s[4:7], s33 offen offset:0
    buffer_load_dwordx4 a[20:23], v36, s[4:7], s33 offen offset:64
    buffer_load_dwordx4 a[24:27], v36, s[4:7], s33 offen offset:128
    buffer_load_dwordx4 a[28:31], v36, s[4:7], s33 offen offset:192
    buffer_load_dwordx4 a[32:35], v37, s[4:7], s32 offen offset:0
    buffer_load_dwordx4 a[36:39], v37, s[4:7], s32 offen offset:64
    buffer_load_dwordx4 a[40:43], v37, s[4:7], s32 offen offset:128
    buffer_load_dwordx4 a[44:47], v37, s[4:7], s32 offen offset:192
    buffer_load_dwordx4 a[48:51], v37, s[4:7], s33 offen offset:0
    buffer_load_dwordx4 a[52:55], v37, s[4:7], s33 offen offset:64
    buffer_load_dwordx4 a[56:59], v37, s[4:7], s33 offen offset:128
    buffer_load_dwordx4 a[60:63], v37, s[4:7], s33 offen offset:192
    v_mov_b32 v21, 0xff800000
    v_mov_b32 v25, 0xff800000
    v_mov_b32 v29, 0xff800000
    v_mov_b32 v33, 0xff800000
    s_lshl_b32 s57, s56, 17
    s_mov_b32 s58, 0
L_slow_p1:
    buffer_load_dwordx4 a[128:131], v36, s[8:11], s57 offen offset:0
    buffer_load_dwordx4 a[132:135], v36, s[8:11], s57 offen offset:64
    buffer_load_dwordx4 a[136:139], v36, s[8:11], s57 offen offset:128
    buffer_load_dwordx4 a[140:143], v36, s[8:11], s57 offen offset:192
    s_waitcnt vmcnt(0)
    v_mfma_f32_16x16x32_bf16 v[40:43], a[128:131], a[0:3], 0
    v_mfma_f32_16x16x32_bf16 v[40:43], a[132:135], a[4:7], v[40:43]
    v_mfma_f32_16x16x32_bf16 v[40:43], a[136:139], a[8:11], v[40:43]
    v_mfma_f32_16x16x32_bf16 v[40:43], a[140:143], a[12:15], v[40:43]
    v_mfma_f32_16x16x32_bf16 v[44:47], a[140:143], a[28:31], 0
    v_mfma_f32_16x16x32_bf16 v[44:47], a[136:139], a[24:27], v[44:47]
    v_mfma_f32_16x16x32_bf16 v[44:47], a[132:135], a[20:23], v[44:47]
    v_mfma_f32_16x16x32_bf16 v[44:47], a[128:131], a[16:19], v[44:47]
    v_mfma_f32_16x16x32_bf16 v[48:51], a[128:131], a[32:35], 0
    v_mfma_f32_16x16x32_bf16 v[48:51], a[132:135], a[36:39], v[48:51]
    v_mfma_f32_16x16x32_bf16 v[48:51], a[136:139], a[40:43], v[48:51]
    v_mfma_f32_16x16x32_bf16 v[48:51], a[140:143], a[44:47], v[48:51]
    v_mfma_f32_16x16x32_bf16 v[56:59], a[140:143], a[60:63], 0
    v_mfma_f32_16x16x32_bf16 v[56:59], a[136:139], a[56:59], v[56:59]
    v_mfma_f32_16x16x32_bf16 v[56:59], a[132:135], a[52:55], v[56:59]
    v_mfma_f32_16x16x32_bf16 v[56:59], a[128:131], a[48:51], v[56:59]
    v_max3_f32 v21, v40, v41, v21
    v_max3_f32 v21, v42, v43, v21
    v_max3_f32 v25, v44, v45, v25
    v_max3_f32 v25, v46, v47, v25
    v_max3_f32 v29, v48, v49, v29
    v_max3_f32 v29, v50, v51, v29
    s_nop 0
    s_nop 0
    v_max3_f32 v33, v56, v57, v33
    v_max3_f32 v33, v58, v59, v33
    s_add_u32 s57, s57, 4096
    s_add_u32 s58, s58, 1
    s_cmp_lt_u32 s58, 32
    s_cbranch_scc1 L_slow_p1
    v_permlane16_swap_b32 v21, v25
    v_permlane16_swap_b32 v29, v33
    v_max_f32 v21, v21, v25
    v_max_f32 v29, v29, v33
    s_nop 0
    s_nop 0
    v_permlane32_swap_b32 v21, v29
    v_max_f32 v21, v21, v29
    v_fma_f32 v20, v21, s35, v10
    v_mov_b32 v28, v20
    s_nop 0
    s_nop 0
    v_permlane32_swap_b32 v20, v28
    v_mov_b32 v24, v20
    v_mov_b32 v32, v28
    s_nop 0
    v_permlane16_swap_b32 v20, v24
    v_permlane16_swap_b32 v28, v32
    v_mov_b32 v128, 0
    v_mov_b32 v129, 0
    v_mov_b32 v130, 0
    v_mov_b32 v131, 0
    v_mov_b32 v132, 0
    v_mov_b32 v133, 0
    v_mov_b32 v134, 0
    v_mov_b32 v135, 0
    v_mov_b32 v136, 0
    v_mov_b32 v137, 0
    v_mov_b32 v138, 0
    v_mov_b32 v139, 0
    v_mov_b32 v140, 0
    v_mov_b32 v141, 0
    v_mov_b32 v142, 0
    v_mov_b32 v143, 0
    v_mov_b32 v144, 0
    v_mov_b32 v145, 0
    v_mov_b32 v146, 0
    v_mov_b32 v147, 0
    v_mov_b32 v148, 0
    v_mov_b32 v149, 0
    v_mov_b32 v150, 0
    v_mov_b32 v151, 0
    v_mov_b32 v152, 0
    v_mov_b32 v153, 0
    v_mov_b32 v154, 0
    v_mov_b32 v155, 0
    v_mov_b32 v156, 0
    v_mov_b32 v157, 0
    v_mov_b32 v158, 0
    v_mov_b32 v159, 0
    v_mov_b32 v160, 0
    v_mov_b32 v161, 0
    v_mov_b32 v162, 0
    v_mov_b32 v163, 0
    v_mov_b32 v164, 0
    v_mov_b32 v165, 0
    v_mov_b32 v166, 0
    v_mov_b32 v167, 0
    v_mov_b32 v168, 0
    v_mov_b32 v169, 0
    v_mov_b32 v170, 0
    v_mov_b32 v171, 0
    v_mov_b32 v172, 0
    v_mov_b32 v173, 0
    v_mov_b32 v174, 0
    v_mov_b32 v175, 0
    v_mov_b32 v176, 0
    v_mov_b32 v177, 0
    v_mov_b32 v178, 0
    v_mov_b32 v179, 0
    v_mov_b32 v180, 0
    v_mov_b32 v181, 0
    v_mov_b32 v182, 0
    v_mov_b32 v183, 0
    v_mov_b32 v184, 0
    v_mov_b32 v185, 0
    v_mov_b32 v186, 0
    v_mov_b32 v187, 0
    v_mov_b32 v188, 0
    v_mov_b32 v189, 0
    v_mov_b32 v190, 0
    v_mov_b32 v191, 0
    v_mov_b32 v192, 0
    v_mov_b32 v193, 0
    v_mov_b32 v194, 0
    v_mov_b32 v195, 0
    v_mov_b32 v196, 0
    v_mov_b32 v197, 0
    v_mov_b32 v198, 0
    v_mov_b32 v199, 0
    v_mov_b32 v200, 0
    v_mov_b32 v201, 0
    v_mov_b32 v202, 0
    v_mov_b32 v203, 0
    v_mov_b32 v204, 0
    v_mov_b32 v205, 0
    v_mov_b32 v206, 0
    v_mov_b32 v207, 0
    v_mov_b32 v208, 0
    v_mov_b32 v209, 0
    v_mov_b32 v210, 0
    v_mov_b32 v211, 0
    v_mov_b32 v212, 0
    v_mov_b32 v213, 0
    v_mov_b32 v214, 0
    v_mov_b32 v215, 0
    v_mov_b32 v216, 0
    v_mov_b32 v217, 0
    v_mov_b32 v218, 0
    v_mov_b32 v219, 0
    v_mov_b32 v220, 0
    v_mov_b32 v221, 0
    v_mov_b32 v222, 0
    v_mov_b32 v223, 0
    v_mov_b32 v224, 0
    v_mov_b32 v225, 0
    v_mov_b32 v226, 0
    v_mov_b32 v227, 0
    v_mov_b32 v228, 0
    v_mov_b32 v229, 0
    v_mov_b32 v230, 0
    v_mov_b32 v231, 0
    v_mov_b32 v232, 0
    v_mov_b32 v233, 0
    v_mov_b32 v234, 0
    v_mov_b32 v235, 0
    v_mov_b32 v236, 0
    v_mov_b32 v237, 0
    v_mov_b32 v238, 0
    v_mov_b32 v239, 0
    v_mov_b32 v240, 0
    v_mov_b32 v241, 0
    v_mov_b32 v242, 0
    v_mov_b32 v243, 0
    v_mov_b32 v244, 0
    v_mov_b32 v245, 0
    v_mov_b32 v246, 0
    v_mov_b32 v247, 0
    v_mov_b32 v248, 0
    v_mov_b32 v249, 0
    v_mov_b32 v250, 0
    v_mov_b32 v251, 0
    v_mov_b32 v252, 0
    v_mov_b32 v253, 0
    v_mov_b32 v254, 0
    v_mov_b32 v255, 0
    v_accvgpr_write_b32 a192, 0
    v_accvgpr_write_b32 a193, 0
    v_accvgpr_write_b32 a194, 0
    v_accvgpr_write_b32 a195, 0
    v_accvgpr_write_b32 a196, 0
    v_accvgpr_write_b32 a197, 0
    v_accvgpr_write_b32 a198, 0
    v_accvgpr_write_b32 a199, 0
    v_accvgpr_write_b32 a200, 0
    v_accvgpr_write_b32 a201, 0
    v_accvgpr_write_b32 a202, 0
    v_accvgpr_write_b32 a203, 0
    v_accvgpr_write_b32 a204, 0
    v_accvgpr_write_b32 a205, 0
    v_accvgpr_write_b32 a206, 0
    v_accvgpr_write_b32 a207, 0
    s_lshl_b32 s57, s56, 17
    s_mov_b32 s58, 0
L_slow_p2:
    s_mov_b32 m0, s66
    s_nop 0
    buffer_load_dwordx4 v5, s[12:15], s57 offen offset:0 lds
    buffer_load_dwordx4 v5, s[12:15], s57 offen offset:1024 lds
    buffer_load_dwordx4 v5, s[12:15], s57 offen offset:2048 lds
    buffer_load_dwordx4 v5, s[12:15], s57 offen offset:3072 lds
    buffer_load_dwordx4 a[128:131], v36, s[8:11], s57 offen offset:0
    buffer_load_dwordx4 a[132:135], v36, s[8:11], s57 offen offset:64
    buffer_load_dwordx4 a[136:139], v36, s[8:11], s57 offen offset:128
    buffer_load_dwordx4 a[140:143], v36, s[8:11], s57 offen offset:192
    s_add_u32 s57, s57, 4096
    s_add_u32 m0, s66, 4096
    s_nop 0
    buffer_load_dwordx4 v5, s[12:15], s57 offen offset:0 lds
    buffer_load_dwordx4 v5, s[12:15], s57 offen offset:1024 lds
    buffer_load_dwordx4 v5, s[12:15], s57 offen offset:2048 lds
    buffer_load_dwordx4 v5, s[12:15], s57 offen offset:3072 lds
    buffer_load_dwordx4 a[144:147], v36, s[8:11], s57 offen offset:0
    buffer_load_dwordx4 a[148:151], v36, s[8:11], s57 offen offset:64
    buffer_load_dwordx4 a[152:155], v36, s[8:11], s57 offen offset:128
    buffer_load_dwordx4 a[156:159], v36, s[8:11], s57 offen offset:192
    s_add_u32 s57, s57, 4096
    s_waitcnt vmcnt(0)
    v_mfma_f32_16x16x32_bf16 v[40:43], a[128:131], a[0:3], 0
    v_mfma_f32_16x16x32_bf16 v[40:43], a[132:135], a[4:7], v[40:43]
    v_mfma_f32_16x16x32_bf16 v[40:43], a[136:139], a[8:11], v[40:43]
    v_mfma_f32_16x16x32_bf16 v[40:43], a[140:143], a[12:15], v[40:43]
    v_mfma_f32_16x16x32_bf16 v[44:47], a[140:143], a[28:31], 0
    v_mfma_f32_16x16x32_bf16 v[44:47], a[136:139], a[24:27], v[44:47]
    v_mfma_f32_16x16x32_bf16 v[44:47], a[132:135], a[20:23], v[44:47]
    v_mfma_f32_16x16x32_bf16 v[44:47], a[128:131], a[16:19], v[44:47]
    v_mfma_f32_16x16x32_bf16 v[48:51], a[128:131], a[32:35], 0
    v_mfma_f32_16x16x32_bf16 v[48:51], a[132:135], a[36:39], v[48:51]
    v_mfma_f32_16x16x32_bf16 v[48:51], a[136:139], a[40:43], v[48:51]
    v_mfma_f32_16x16x32_bf16 v[48:51], a[140:143], a[44:47], v[48:51]
    v_mfma_f32_16x16x32_bf16 v[56:59], a[140:143], a[60:63], 0
    v_mfma_f32_16x16x32_bf16 v[56:59], a[136:139], a[56:59], v[56:59]
    v_mfma_f32_16x16x32_bf16 v[56:59], a[132:135], a[52:55], v[56:59]
    v_mfma_f32_16x16x32_bf16 v[56:59], a[128:131], a[48:51], v[56:59]
    v_fma_f32 v40, v40, s34, v20
    v_fma_f32 v41, v41, s34, v20
    v_fma_f32 v42, v42, s34, v20
    v_fma_f32 v43, v43, s34, v20
    v_exp_f32 v40, v40
    v_exp_f32 v41, v41
    v_exp_f32 v42, v42
    v_exp_f32 v43, v43
    v_cvt_pk_bf16_f32 v64, v40, v41
    v_cvt_pk_bf16_f32 v65, v42, v43
    v_fma_f32 v44, v44, s34, v24
    v_fma_f32 v45, v45, s34, v24
    v_fma_f32 v46, v46, s34, v24
    v_fma_f32 v47, v47, s34, v24
    v_exp_f32 v44, v44
    v_exp_f32 v45, v45
    v_exp_f32 v46, v46
    v_exp_f32 v47, v47
    v_cvt_pk_bf16_f32 v68, v44, v45
    v_cvt_pk_bf16_f32 v69, v46, v47
    v_fma_f32 v48, v48, s34, v28
    v_fma_f32 v49, v49, s34, v28
    v_fma_f32 v50, v50, s34, v28
    v_fma_f32 v51, v51, s34, v28
    v_exp_f32 v48, v48
    v_exp_f32 v49, v49
    v_exp_f32 v50, v50
    v_exp_f32 v51, v51
    v_cvt_pk_bf16_f32 v72, v48, v49
    v_cvt_pk_bf16_f32 v73, v50, v51
    v_fma_f32 v56, v56, s34, v32
    v_fma_f32 v57, v57, s34, v32
    v_fma_f32 v58, v58, s34, v32
    v_fma_f32 v59, v59, s34, v32
    v_exp_f32 v56, v56
    v_exp_f32 v57, v57
    v_exp_f32 v58, v58
    v_exp_f32 v59, v59
    v_cvt_pk_bf16_f32 v76, v56, v57
    v_cvt_pk_bf16_f32 v77, v58, v59
    v_mfma_f32_16x16x32_bf16 v[40:43], a[144:147], a[0:3], 0
    v_mfma_f32_16x16x32_bf16 v[40:43], a[148:151], a[4:7], v[40:43]
    v_mfma_f32_16x16x32_bf16 v[40:43], a[152:155], a[8:11], v[40:43]
    v_mfma_f32_16x16x32_bf16 v[40:43], a[156:159], a[12:15], v[40:43]
    v_mfma_f32_16x16x32_bf16 v[44:47], a[156:159], a[28:31], 0
    v_mfma_f32_16x16x32_bf16 v[44:47], a[152:155], a[24:27], v[44:47]
    v_mfma_f32_16x16x32_bf16 v[44:47], a[148:151], a[20:23], v[44:47]
    v_mfma_f32_16x16x32_bf16 v[44:47], a[144:147], a[16:19], v[44:47]
    v_mfma_f32_16x16x32_bf16 v[52:55], a[144:147], a[32:35], 0
    v_mfma_f32_16x16x32_bf16 v[52:55], a[148:151], a[36:39], v[52:55]
    v_mfma_f32_16x16x32_bf16 v[52:55], a[152:155], a[40:43], v[52:55]
    v_mfma_f32_16x16x32_bf16 v[52:55], a[156:159], a[44:47], v[52:55]
    v_mfma_f32_16x16x32_bf16 v[60:63], a[156:159], a[60:63], 0
    v_mfma_f32_16x16x32_bf16 v[60:63], a[152:155], a[56:59], v[60:63]
    v_mfma_f32_16x16x32_bf16 v[60:63], a[148:151], a[52:55], v[60:63]
    v_mfma_f32_16x16x32_bf16 v[60:63], a[144:147], a[48:51], v[60:63]
    v_fma_f32 v40, v40, s34, v20
    v_fma_f32 v41, v41, s34, v20
    v_fma_f32 v42, v42, s34, v20
    v_fma_f32 v43, v43, s34, v20
    v_exp_f32 v40, v40
    v_exp_f32 v41, v41
    v_exp_f32 v42, v42
    v_exp_f32 v43, v43
    v_cvt_pk_bf16_f32 v66, v40, v41
    v_cvt_pk_bf16_f32 v67, v42, v43
    v_fma_f32 v44, v44, s34, v24
    v_fma_f32 v45, v45, s34, v24
    v_fma_f32 v46, v46, s34, v24
    v_fma_f32 v47, v47, s34, v24
    v_exp_f32 v44, v44
    v_exp_f32 v45, v45
    v_exp_f32 v46, v46
    v_exp_f32 v47, v47
    v_cvt_pk_bf16_f32 v70, v44, v45
    v_cvt_pk_bf16_f32 v71, v46, v47
    v_fma_f32 v52, v52, s34, v28
    v_fma_f32 v53, v53, s34, v28
    v_fma_f32 v54, v54, s34, v28
    v_fma_f32 v55, v55, s34, v28
    v_exp_f32 v52, v52
    v_exp_f32 v53, v53
    v_exp_f32 v54, v54
    v_exp_f32 v55, v55
    v_cvt_pk_bf16_f32 v74, v52, v53
    v_cvt_pk_bf16_f32 v75, v54, v55
    v_fma_f32 v60, v60, s34, v32
    v_fma_f32 v61, v61, s34, v32
    v_fma_f32 v62, v62, s34, v32
    v_fma_f32 v63, v63, s34, v32
    v_exp_f32 v60, v60
    v_exp_f32 v61, v61
    v_exp_f32 v62, v62
    v_exp_f32 v63, v63
    v_cvt_pk_bf16_f32 v78, v60, v61
    v_cvt_pk_bf16_f32 v79, v62, v63
    v_mfma_f32_16x16x32_bf16 a[192:195], a[208:211], v[64:67], a[192:195]
    v_mfma_f32_16x16x32_bf16 a[196:199], a[208:211], v[68:71], a[196:199]
    v_mfma_f32_16x16x32_bf16 a[200:203], a[208:211], v[72:75], a[200:203]
    v_mfma_f32_16x16x32_bf16 a[204:207], a[208:211], v[76:79], a[204:207]
    ds_read_b64_tr_b16 a[160:161], v38 offset:0
    ds_read_b64_tr_b16 a[162:163], v38 offset:4096
    ds_read_b64_tr_b16 a[168:169], v38 offset:8
    ds_read_b64_tr_b16 a[170:171], v38 offset:4104
    s_waitcnt lgkmcnt(0)
    v_mfma_f32_16x16x32_bf16 v[128:131], a[160:163], v[64:67], v[128:131]
    v_mfma_f32_16x16x32_bf16 v[132:135], a[160:163], v[68:71], v[132:135]
    v_mfma_f32_16x16x32_bf16 v[136:139], a[160:163], v[72:75], v[136:139]
    v_mfma_f32_16x16x32_bf16 v[140:143], a[160:163], v[76:79], v[140:143]
    v_mfma_f32_16x16x32_bf16 v[144:147], a[168:171], v[64:67], v[144:147]
    v_mfma_f32_16x16x32_bf16 v[148:151], a[168:171], v[68:71], v[148:151]
    v_mfma_f32_16x16x32_bf16 v[152:155], a[168:171], v[72:75], v[152:155]
    v_mfma_f32_16x16x32_bf16 v[156:159], a[168:171], v[76:79], v[156:159]
    s_nop 7
    ds_read_b64_tr_b16 a[160:161], v38 offset:256
    ds_read_b64_tr_b16 a[162:163], v38 offset:4352
    ds_read_b64_tr_b16 a[168:169], v38 offset:264
    ds_read_b64_tr_b16 a[170:171], v38 offset:4360
    s_waitcnt lgkmcnt(0)
    v_mfma_f32_16x16x32_bf16 v[160:163], a[160:163], v[64:67], v[160:163]
    v_mfma_f32_16x16x32_bf16 v[164:167], a[160:163], v[68:71], v[164:167]
    v_mfma_f32_16x16x32_bf16 v[168:171], a[160:163], v[72:75], v[168:171]
    v_mfma_f32_16x16x32_bf16 v[172:175], a[160:163], v[76:79], v[172:175]
    v_mfma_f32_16x16x32_bf16 v[176:179], a[168:171], v[64:67], v[176:179]
    v_mfma_f32_16x16x32_bf16 v[180:183], a[168:171], v[68:71], v[180:183]
    v_mfma_f32_16x16x32_bf16 v[184:187], a[168:171], v[72:75], v[184:187]
    v_mfma_f32_16x16x32_bf16 v[188:191], a[168:171], v[76:79], v[188:191]
    s_nop 7
    ds_read_b64_tr_b16 a[160:161], v38 offset:512
    ds_read_b64_tr_b16 a[162:163], v38 offset:4608
    ds_read_b64_tr_b16 a[168:169], v38 offset:520
    ds_read_b64_tr_b16 a[170:171], v38 offset:4616
    s_waitcnt lgkmcnt(0)
    v_mfma_f32_16x16x32_bf16 v[192:195], a[160:163], v[64:67], v[192:195]
    v_mfma_f32_16x16x32_bf16 v[196:199], a[160:163], v[68:71], v[196:199]
    v_mfma_f32_16x16x32_bf16 v[200:203], a[160:163], v[72:75], v[200:203]
    v_mfma_f32_16x16x32_bf16 v[204:207], a[160:163], v[76:79], v[204:207]
    v_mfma_f32_16x16x32_bf16 v[208:211], a[168:171], v[64:67], v[208:211]
    v_mfma_f32_16x16x32_bf16 v[212:215], a[168:171], v[68:71], v[212:215]
    v_mfma_f32_16x16x32_bf16 v[216:219], a[168:171], v[72:75], v[216:219]
    v_mfma_f32_16x16x32_bf16 v[220:223], a[168:171], v[76:79], v[220:223]
    s_nop 7
    ds_read_b64_tr_b16 a[160:161], v38 offset:768
    ds_read_b64_tr_b16 a[162:163], v38 offset:4864
    ds_read_b64_tr_b16 a[168:169], v38 offset:776
    ds_read_b64_tr_b16 a[170:171], v38 offset:4872
    s_waitcnt lgkmcnt(0)
    v_mfma_f32_16x16x32_bf16 v[224:227], a[160:163], v[64:67], v[224:227]
    v_mfma_f32_16x16x32_bf16 v[228:231], a[160:163], v[68:71], v[228:231]
    v_mfma_f32_16x16x32_bf16 v[232:235], a[160:163], v[72:75], v[232:235]
    v_mfma_f32_16x16x32_bf16 v[236:239], a[160:163], v[76:79], v[236:239]
    v_mfma_f32_16x16x32_bf16 v[240:243], a[168:171], v[64:67], v[240:243]
    v_mfma_f32_16x16x32_bf16 v[244:247], a[168:171], v[68:71], v[244:247]
    v_mfma_f32_16x16x32_bf16 v[248:251], a[168:171], v[72:75], v[248:251]
    v_mfma_f32_16x16x32_bf16 v[252:255], a[168:171], v[76:79], v[252:255]
    s_nop 7
    s_add_u32 s58, s58, 1
    s_cmp_lt_u32 s58, 16
    s_cbranch_scc1 L_slow_p2
    s_nop 7
    v_accvgpr_read_b32 v14, a192
    v_cmp_nge_f32 s[48:49], s36, v14
    v_rcp_f32 v14, v14
    v_accvgpr_read_b32 v15, a196
    v_cmp_nge_f32 s[50:51], s36, v15
    v_rcp_f32 v15, v15
    v_accvgpr_read_b32 v16, a200
    v_cmp_nge_f32 s[52:53], s36, v16
    v_rcp_f32 v16, v16
    v_accvgpr_read_b32 v17, a204
    v_cmp_nge_f32 s[54:55], s36, v17
    v_rcp_f32 v17, v17
    v_mul_f32 v128, v128, v14
    v_mul_f32 v129, v129, v14
    v_mul_f32 v130, v130, v14
    v_mul_f32 v131, v131, v14
    v_mul_f32 v144, v144, v14
    v_mul_f32 v145, v145, v14
    v_mul_f32 v146, v146, v14
    v_mul_f32 v147, v147, v14
    v_cvt_pk_bf16_f32 v128, v128, v129
    v_cvt_pk_bf16_f32 v129, v130, v131
    v_cvt_pk_bf16_f32 v130, v144, v145
    v_cvt_pk_bf16_f32 v131, v146, v147
    ds_write_b128 v12, v[128:131] offset:0
    v_mul_f32 v132, v132, v15
    v_mul_f32 v133, v133, v15
    v_mul_f32 v134, v134, v15
    v_mul_f32 v135, v135, v15
    v_mul_f32 v148, v148, v15
    v_mul_f32 v149, v149, v15
    v_mul_f32 v150, v150, v15
    v_mul_f32 v151, v151, v15
    v_cvt_pk_bf16_f32 v132, v132, v133
    v_cvt_pk_bf16_f32 v133, v134, v135
    v_cvt_pk_bf16_f32 v134, v148, v149
    v_cvt_pk_bf16_f32 v135, v150, v151
    ds_write_b128 v12, v[132:135] offset:2048
    v_mul_f32 v136, v136, v16
    v_mul_f32 v137, v137, v16
    v_mul_f32 v138, v138, v16
    v_mul_f32 v139, v139, v16
    v_mul_f32 v152, v152, v16
    v_mul_f32 v153, v153, v16
    v_mul_f32 v154, v154, v16
    v_mul_f32 v155, v155, v16
    v_cvt_pk_bf16_f32 v136, v136, v137
    v_cvt_pk_bf16_f32 v137, v138, v139
    v_cvt_pk_bf16_f32 v138, v152, v153
    v_cvt_pk_bf16_f32 v139, v154, v155
    ds_write_b128 v12, v[136:139] offset:4096
    v_mul_f32 v140, v140, v17
    v_mul_f32 v141, v141, v17
    v_mul_f32 v142, v142, v17
    v_mul_f32 v143, v143, v17
    v_mul_f32 v156, v156, v17
    v_mul_f32 v157, v157, v17
    v_mul_f32 v158, v158, v17
    v_mul_f32 v159, v159, v17
    v_cvt_pk_bf16_f32 v140, v140, v141
    v_cvt_pk_bf16_f32 v141, v142, v143
    v_cvt_pk_bf16_f32 v142, v156, v157
    v_cvt_pk_bf16_f32 v143, v158, v159
    ds_write_b128 v12, v[140:143] offset:6144
    v_mul_f32 v160, v160, v14
    v_mul_f32 v161, v161, v14
    v_mul_f32 v162, v162, v14
    v_mul_f32 v163, v163, v14
    v_mul_f32 v176, v176, v14
    v_mul_f32 v177, v177, v14
    v_mul_f32 v178, v178, v14
    v_mul_f32 v179, v179, v14
    v_cvt_pk_bf16_f32 v160, v160, v161
    v_cvt_pk_bf16_f32 v161, v162, v163
    v_cvt_pk_bf16_f32 v162, v176, v177
    v_cvt_pk_bf16_f32 v163, v178, v179
    ds_write_b128 v13, v[160:163] offset:0
    v_mul_f32 v164, v164, v15
    v_mul_f32 v165, v165, v15
    v_mul_f32 v166, v166, v15
    v_mul_f32 v167, v167, v15
    v_mul_f32 v180, v180, v15
    v_mul_f32 v181, v181, v15
    v_mul_f32 v182, v182, v15
    v_mul_f32 v183, v183, v15
    v_cvt_pk_bf16_f32 v164, v164, v165
    v_cvt_pk_bf16_f32 v165, v166, v167
    v_cvt_pk_bf16_f32 v166, v180, v181
    v_cvt_pk_bf16_f32 v167, v182, v183
    ds_write_b128 v13, v[164:167] offset:2048
    v_mul_f32 v168, v168, v16
    v_mul_f32 v169, v169, v16
    v_mul_f32 v170, v170, v16
    v_mul_f32 v171, v171, v16
    v_mul_f32 v184, v184, v16
    v_mul_f32 v185, v185, v16
    v_mul_f32 v186, v186, v16
    v_mul_f32 v187, v187, v16
    v_cvt_pk_bf16_f32 v168, v168, v169
    v_cvt_pk_bf16_f32 v169, v170, v171
    v_cvt_pk_bf16_f32 v170, v184, v185
    v_cvt_pk_bf16_f32 v171, v186, v187
    ds_write_b128 v13, v[168:171] offset:4096
    v_mul_f32 v172, v172, v17
    v_mul_f32 v173, v173, v17
    v_mul_f32 v174, v174, v17
    v_mul_f32 v175, v175, v17
    v_mul_f32 v188, v188, v17
    v_mul_f32 v189, v189, v17
    v_mul_f32 v190, v190, v17
    v_mul_f32 v191, v191, v17
    v_cvt_pk_bf16_f32 v172, v172, v173
    v_cvt_pk_bf16_f32 v173, v174, v175
    v_cvt_pk_bf16_f32 v174, v188, v189
    v_cvt_pk_bf16_f32 v175, v190, v191
    ds_write_b128 v13, v[172:175] offset:6144
    ds_read_b128 a[96:99], v11 offset:0
    ds_read_b128 a[100:103], v11 offset:1024
    ds_read_b128 a[104:107], v11 offset:2048
    ds_read_b128 a[108:111], v11 offset:3072
    s_waitcnt lgkmcnt(0)
    buffer_store_dwordx4 a[96:99], v3, s[16:19], s32 offen offset:0 nt
    buffer_store_dwordx4 a[100:103], v3, s[16:19], s32 offen offset:2048 nt
    buffer_store_dwordx4 a[104:107], v3, s[16:19], s33 offen offset:0 nt
    buffer_store_dwordx4 a[108:111], v3, s[16:19], s33 offen offset:2048 nt
    ds_read_b128 a[112:115], v11 offset:4096
    ds_read_b128 a[116:119], v11 offset:5120
    ds_read_b128 a[120:123], v11 offset:6144
    ds_read_b128 a[124:127], v11 offset:7168
    s_waitcnt lgkmcnt(0)
    buffer_store_dwordx4 a[112:115], v4, s[16:19], s32 offen offset:0 nt
    buffer_store_dwordx4 a[116:119], v4, s[16:19], s32 offen offset:2048 nt
    buffer_store_dwordx4 a[120:123], v4, s[16:19], s33 offen offset:0 nt
    buffer_store_dwordx4 a[124:127], v4, s[16:19], s33 offen offset:2048 nt
    v_mul_f32 v192, v192, v14
    v_mul_f32 v193, v193, v14
    v_mul_f32 v194, v194, v14
    v_mul_f32 v195, v195, v14
    v_mul_f32 v208, v208, v14
    v_mul_f32 v209, v209, v14
    v_mul_f32 v210, v210, v14
    v_mul_f32 v211, v211, v14
    v_cvt_pk_bf16_f32 v192, v192, v193
    v_cvt_pk_bf16_f32 v193, v194, v195
    v_cvt_pk_bf16_f32 v194, v208, v209
    v_cvt_pk_bf16_f32 v195, v210, v211
    ds_write_b128 v12, v[192:195] offset:0
    v_mul_f32 v196, v196, v15
    v_mul_f32 v197, v197, v15
    v_mul_f32 v198, v198, v15
    v_mul_f32 v199, v199, v15
    v_mul_f32 v212, v212, v15
    v_mul_f32 v213, v213, v15
    v_mul_f32 v214, v214, v15
    v_mul_f32 v215, v215, v15
    v_cvt_pk_bf16_f32 v196, v196, v197
    v_cvt_pk_bf16_f32 v197, v198, v199
    v_cvt_pk_bf16_f32 v198, v212, v213
    v_cvt_pk_bf16_f32 v199, v214, v215
    ds_write_b128 v12, v[196:199] offset:2048
    v_mul_f32 v200, v200, v16
    v_mul_f32 v201, v201, v16
    v_mul_f32 v202, v202, v16
    v_mul_f32 v203, v203, v16
    v_mul_f32 v216, v216, v16
    v_mul_f32 v217, v217, v16
    v_mul_f32 v218, v218, v16
    v_mul_f32 v219, v219, v16
    v_cvt_pk_bf16_f32 v200, v200, v201
    v_cvt_pk_bf16_f32 v201, v202, v203
    v_cvt_pk_bf16_f32 v202, v216, v217
    v_cvt_pk_bf16_f32 v203, v218, v219
    ds_write_b128 v12, v[200:203] offset:4096
    v_mul_f32 v204, v204, v17
    v_mul_f32 v205, v205, v17
    v_mul_f32 v206, v206, v17
    v_mul_f32 v207, v207, v17
    v_mul_f32 v220, v220, v17
    v_mul_f32 v221, v221, v17
    v_mul_f32 v222, v222, v17
    v_mul_f32 v223, v223, v17
    v_cvt_pk_bf16_f32 v204, v204, v205
    v_cvt_pk_bf16_f32 v205, v206, v207
    v_cvt_pk_bf16_f32 v206, v220, v221
    v_cvt_pk_bf16_f32 v207, v222, v223
    ds_write_b128 v12, v[204:207] offset:6144
    v_mul_f32 v224, v224, v14
    v_mul_f32 v225, v225, v14
    v_mul_f32 v226, v226, v14
    v_mul_f32 v227, v227, v14
    v_mul_f32 v240, v240, v14
    v_mul_f32 v241, v241, v14
    v_mul_f32 v242, v242, v14
    v_mul_f32 v243, v243, v14
    v_cvt_pk_bf16_f32 v224, v224, v225
    v_cvt_pk_bf16_f32 v225, v226, v227
    v_cvt_pk_bf16_f32 v226, v240, v241
    v_cvt_pk_bf16_f32 v227, v242, v243
    ds_write_b128 v13, v[224:227] offset:0
    v_mul_f32 v228, v228, v15
    v_mul_f32 v229, v229, v15
    v_mul_f32 v230, v230, v15
    v_mul_f32 v231, v231, v15
    v_mul_f32 v244, v244, v15
    v_mul_f32 v245, v245, v15
    v_mul_f32 v246, v246, v15
    v_mul_f32 v247, v247, v15
    v_cvt_pk_bf16_f32 v228, v228, v229
    v_cvt_pk_bf16_f32 v229, v230, v231
    v_cvt_pk_bf16_f32 v230, v244, v245
    v_cvt_pk_bf16_f32 v231, v246, v247
    ds_write_b128 v13, v[228:231] offset:2048
    v_mul_f32 v232, v232, v16
    v_mul_f32 v233, v233, v16
    v_mul_f32 v234, v234, v16
    v_mul_f32 v235, v235, v16
    v_mul_f32 v248, v248, v16
    v_mul_f32 v249, v249, v16
    v_mul_f32 v250, v250, v16
    v_mul_f32 v251, v251, v16
    v_cvt_pk_bf16_f32 v232, v232, v233
    v_cvt_pk_bf16_f32 v233, v234, v235
    v_cvt_pk_bf16_f32 v234, v248, v249
    v_cvt_pk_bf16_f32 v235, v250, v251
    ds_write_b128 v13, v[232:235] offset:4096
    v_mul_f32 v236, v236, v17
    v_mul_f32 v237, v237, v17
    v_mul_f32 v238, v238, v17
    v_mul_f32 v239, v239, v17
    v_mul_f32 v252, v252, v17
    v_mul_f32 v253, v253, v17
    v_mul_f32 v254, v254, v17
    v_mul_f32 v255, v255, v17
    v_cvt_pk_bf16_f32 v236, v236, v237
    v_cvt_pk_bf16_f32 v237, v238, v239
    v_cvt_pk_bf16_f32 v238, v252, v253
    v_cvt_pk_bf16_f32 v239, v254, v255
    ds_write_b128 v13, v[236:239] offset:6144
    ds_read_b128 a[212:215], v11 offset:0
    ds_read_b128 a[216:219], v11 offset:1024
    ds_read_b128 a[220:223], v11 offset:2048
    ds_read_b128 a[224:227], v11 offset:3072
    s_waitcnt lgkmcnt(0)
    buffer_store_dwordx4 a[212:215], v3, s[16:19], s32 offen offset:128 nt
    buffer_store_dwordx4 a[216:219], v3, s[16:19], s32 offen offset:2176 nt
    buffer_store_dwordx4 a[220:223], v3, s[16:19], s33 offen offset:128 nt
    buffer_store_dwordx4 a[224:227], v3, s[16:19], s33 offen offset:2176 nt
    ds_read_b128 a[228:231], v11 offset:4096
    ds_read_b128 a[232:235], v11 offset:5120
    ds_read_b128 a[236:239], v11 offset:6144
    ds_read_b128 a[240:243], v11 offset:7168
    s_waitcnt lgkmcnt(0)
    buffer_store_dwordx4 a[228:231], v4, s[16:19], s32 offen offset:128 nt
    buffer_store_dwordx4 a[232:235], v4, s[16:19], s32 offen offset:2176 nt
    buffer_store_dwordx4 a[236:239], v4, s[16:19], s33 offen offset:128 nt
    buffer_store_dwordx4 a[240:243], v4, s[16:19], s33 offen offset:2176 nt
    s_waitcnt vmcnt(0)
L_slow_next:
    s_add_u32 s37, s37, 1
    s_cmp_lt_u32 s37, 4
    s_cbranch_scc1 L_slow_blk
L_end:
    s_endpgm
.section .rodata,"a"
.p2align 6
.amdhsa_kernel standalone__gqa_softmax__near_ridge_kernel
  .amdhsa_next_free_vgpr 512
  .amdhsa_next_free_sgpr 96
  .amdhsa_accum_offset 256
  .amdhsa_group_segment_fixed_size 0
  .amdhsa_kernarg_size 48
  .amdhsa_user_sgpr_count 2
  .amdhsa_user_sgpr_kernarg_segment_ptr 1
  .amdhsa_system_sgpr_workgroup_id_x 1
.end_amdhsa_kernel
```
